```python
import torch

def _softmax(x, axis=-1):
    return torch.softmax(x, dim=axis)

def _gelu(x):
    return torch.nn.functional.gelu(x, approximate='tanh')

def _silu(x):
    return torch.nn.functional.silu(x)

def _sigmoid(x):
    return torch.sigmoid(x)

def _layernorm(x, axis=-1, eps=1e-05):
    m = x.mean(dim=axis, keepdim=True)
    v = x.var(dim=axis, keepdim=True, unbiased=False)
    return (x - m) / torch.sqrt(v + eps)

def _scatter_add(tgt, idx, src, axis=0):
    return tgt.clone().index_add_(axis, idx, src)

def _segment_sum(src, seg, n):
    out = torch.zeros((n,) + src.shape[1:], dtype=src.dtype)
    return out.index_add_(0, seg, src)

def _pad(x, pw):
    flat = tuple((v for pair in reversed(pw) for v in pair))
    return torch.nn.functional.pad(x, flat)
kernel_name = 'adaLN_cond__mha_block__moe_arch_mod__prompt'

def setup_inputs():

    _w = lambda a: (lambda t: t.to(torch.bfloat16) if t.is_floating_point() else t)(torch.as_tensor(a))

    def _A_setup():
        B, S, D, H = (1, 2048, 512, 32)
        return {'x': _w((lambda *s: torch.randn(*s, dtype=torch.bfloat16) * 0.05)(B, S, D)), 'wqkv': _w((lambda *s: torch.randn(*s, dtype=torch.bfloat16) * 0.05)(D, 3 * D)), 'wo': _w((lambda *s: torch.randn(*s, dtype=torch.bfloat16) * 0.05)(D, D))}
    _A_in = _A_setup()

    def _B_setup():
        B, S, D, F, C = (1, 2048, 512, 1792, 1)
        return {'x': _w((lambda *s: torch.randn(*s, dtype=torch.bfloat16) * 0.05)(B, S, D)), 'w_r': _w((lambda *s: torch.randn(*s, dtype=torch.bfloat16) * 0.05)(D)), 'w_gate': _w((lambda *s: torch.randn(*s, dtype=torch.bfloat16) * 0.05)(D, F)), 'w_up': _w((lambda *s: torch.randn(*s, dtype=torch.bfloat16) * 0.05)(D, F)), 'w_down': _w((lambda *s: torch.randn(*s, dtype=torch.bfloat16) * 0.05)(F, D))}
    _B_in = _B_setup()
    return {'A_x': _A_in['x'], 'A_wqkv': _A_in['wqkv'], 'A_wo': _A_in['wo'], 'B_x': _B_in['x'], 'B_w_r': _B_in['w_r'], 'B_w_gate': _B_in['w_gate'], 'B_w_up': _B_in['w_up'], 'B_w_down': _B_in['w_down'], 'c': _w((lambda *s: torch.randn(*s, dtype=torch.bfloat16) * 0.1)(1, 512) * 8.0), 'w_mod': _w((lambda *s: torch.randn(*s, dtype=torch.bfloat16) * 0.1)(512, 6 * 512) * 512 ** (-0.5) * 8.0)}

def reference(A_x, A_wqkv, A_wo, B_x, B_w_r, B_w_gate, B_w_up, B_w_down, c, w_mod):

    def _A_ref(x, wqkv, wo):
        B, S, D = x.shape
        H = 32
        Dh = D // H
        qkv = (lambda x, *d: x.permute(*d))((x @ wqkv).reshape(B, S, 3, H, Dh), 2, 0, 3, 1, 4)
        q, k, v = (qkv[0], qkv[1], qkv[2])
        scores = torch.einsum('bhqd,bhkd->bhqk', q, k) * Dh ** (-0.5)
        p = _softmax(scores, axis=-1)
        o = torch.einsum('bhqk,bhkd->bhqd', p, v)
        return (lambda x, *d: x.permute(*d))(o, 0, 2, 1, 3).reshape(B, S, D) @ wo

    def _B_ref(x, w_r, w_gate, w_up, w_down):
        B, S, D = x.shape
        C = 1
        r = x @ w_r
        idx = torch.argsort(-r, axis=-1)[:, :C]
        idx_e = (lambda x, n, axis: torch.repeat_interleave(x, n, dim=axis))(idx.reshape(B, C, 1), D, axis=2)
        x_sel = (lambda x, i, axis: torch.take_along_dim(x, i, dim=axis))(x, idx_e, axis=1)
        g = _silu(x_sel @ w_gate)
        u = x_sel @ w_up
        y = g * u @ w_down
        r_sel = _sigmoid((lambda x, i, axis: torch.take_along_dim(x, i, dim=axis))(r, idx, axis=1))
        y = y * r_sel.reshape(B, C, 1)
        b_off = (torch.arange(B) * S).reshape(B, 1)
        flat_idx = (idx + b_off).reshape(B * C)
        zero = (x * 0.0).reshape(B * S, D)
        upd = _scatter_add(zero, flat_idx, y.reshape(B * C, D), axis=0)
        return x + upd.reshape(B, S, D)
    x = A_x
    mod = (_silu(c) @ w_mod).reshape(c.shape[0], 6, 1, -1)
    sa, ca, ga, sb, cb, gb = (mod[:, 0].clone(), mod[:, 1].clone(), mod[:, 2].clone(), mod[:, 3].clone(), mod[:, 4].clone(), mod[:, 5].clone())
    h = _layernorm(x, axis=-1) * (1 + ca) + sa
    x = x + ga * _A_ref(h, A_wqkv, A_wo)
    h = _layernorm(x, axis=-1) * (1 + cb) + sb
    x = x + gb * _B_ref(h, B_w_r, B_w_gate, B_w_up, B_w_down)
    return x
```

```asm
; @launch grid=(256,1,1) block=(512,1,1) lds=163840
.amdgcn_target "amdgcn-amd-amdhsa--gfx950"
.text
.globl adaLN_cond__mha_block__moe_arch_mod__prompt_kernel
.p2align 8
.type adaLN_cond__mha_block__moe_arch_mod__prompt_kernel,@function
adaLN_cond__mha_block__moe_arch_mod__prompt_kernel:
  s_cmp_ge_u32 s2, 256
  s_cbranch_scc1 L_end
  s_load_dwordx2 s[32:33], s[0:1], 64
  s_load_dwordx2 s[28:29], s[0:1], 72
  s_load_dwordx2 s[20:21], s[0:1], 96
  s_load_dwordx2 s[8:9], s[0:1], 0
  s_load_dwordx2 s[12:13], s[0:1], 8
  s_getpc_b64 s[4:5]
L_cpf:
  s_sub_u32 s4, s4, L_cpf-adaLN_cond__mha_block__moe_arch_mod__prompt_kernel
  s_subb_u32 s5, s5, 0
  s_mov_b32 s6, L_code_end-adaLN_cond__mha_block__moe_arch_mod__prompt_kernel
  s_mov_b32 s7, 0x20000
  v_lshrrev_b32 v2, 6, v0
  s_add_u32 s3, s2, 0
  s_and_b32 s3, s3, 0xf8
  v_add_u32 v249, s3, v2
  v_lshlrev_b32 v249, 7, v249
  buffer_load_dword v249, v249, s[4:7], 0 offen
  s_mov_b32 s10, 0x200000
  s_mov_b32 s11, 0x20000
  s_mov_b32 s14, 0x180000
  s_mov_b32 s15, 0x20000
  s_mov_b32 s18, 0x80000
  s_mov_b32 s19, 0x20000
  s_mov_b32 s22, 0xb00000
  s_mov_b32 s23, 0x20000
  s_mov_b32 s26, 0x200000
  s_mov_b32 s27, 0x20000
  s_mov_b32 s30, 0x300000
  s_mov_b32 s31, 0x20000
  s_mov_b32 s34, 0x400
  s_mov_b32 s35, 0x20000
  s_mov_b32 s38, 0x400
  s_mov_b32 s39, 0x20000
  s_mov_b32 s42, 0x1c0000
  s_mov_b32 s43, 0x20000
  s_mov_b32 s46, 0x1c0000
  s_mov_b32 s47, 0x20000
  s_mov_b32 s50, 0x1c0000
  s_mov_b32 s51, 0x20000
  v_and_b32 v1, 63, v0
  v_lshrrev_b32 v2, 6, v0
  s_and_b32 s54, s2, 7
  s_lshr_b32 s55, s2, 3
  v_readfirstlane_b32 s52, v2
  s_mov_b32 s80, 0xffff0000
  s_mov_b32 s81, 400000
  s_mov_b32 s84, 0x0000ffff
  s_mov_b32 s85, 0x0000ffff
  s_mov_b32 s100, -1
  s_mov_b32 s101, 0
  s_mov_b32 s86, 8192
  s_mov_b32 s87, 16384
  s_mov_b32 s88, 24576
  s_mov_b32 s98, 0
  s_lshr_b32 s66, s55, 2
  s_and_b32 s68, s55, 3
  s_lshl_b32 s62, s54, 4
  s_add_u32 s62, s62, s55
  s_cmp_lt_u32 s55, 16
  s_cselect_b32 s62, s62, 64
  s_and_b32 s69, s54, 3
  s_lshl_b32 s69, s69, 2
  s_add_u32 s56, s69, s68
  s_lshr_b32 s69, s54, 2
  s_lshl_b32 s69, s69, 3
  s_add_u32 s57, s69, s66
  s_lshl_b32 s69, s54, 2
  s_add_u32 s58, s69, s68
  s_mov_b32 s59, s66
  s_lshl_b32 s69, s54, 3
  s_add_u32 s60, s69, s66
  s_mov_b32 s61, s68
  s_lshr_b32 s63, s52, 2
  s_and_b32 s64, s52, 3
  s_cmp_ge_u32 s62, 64
  s_cbranch_scc1 L_touch_skip
  s_mov_b64 exec, 0
  s_cmp_eq_u32 s52, 0
  s_cbranch_scc1 L_pad_0
  s_cmp_eq_u32 s52, 1
  s_cbranch_scc1 L_pad_2
  s_cmp_eq_u32 s52, 2
  s_cbranch_scc1 L_pad_4
  s_cmp_eq_u32 s52, 3
  s_cbranch_scc1 L_pad_6
  s_cmp_eq_u32 s52, 4
  s_cbranch_scc1 L_pad_8
  s_cmp_eq_u32 s52, 5
  s_cbranch_scc1 L_pad_10
  s_cmp_eq_u32 s52, 6
  s_cbranch_scc1 L_pad_12
  s_cmp_eq_u32 s52, 7
  s_cbranch_scc1 L_pad_14
L_touch_ret:
  s_mov_b64 exec, -1
L_touch_skip:
  s_waitcnt lgkmcnt(0)
  s_load_dword s65, s[20:21], 0
  s_load_dwordx2 s[16:17], s[0:1], 16
  s_load_dwordx2 s[36:37], s[0:1], 32
  s_load_dwordx2 s[40:41], s[0:1], 40
  s_load_dwordx2 s[44:45], s[0:1], 48
  s_load_dwordx2 s[48:49], s[0:1], 56
  s_load_dwordx2 s[24:25], s[0:1], 80
  s_lshr_b32 s66, s55, 2
  s_add_u32 s96, s66, s55
  s_and_b32 s96, s96, 3
  s_lshl_b32 s66, s57, 6
  s_sub_u32 s67, s52, 1
  s_lshl_b32 s92, s67, 14
  s_lshl_b32 s97, s67, 10
  s_cmp_ge_u32 s67, 3
  s_cselect_b32 s68, 783360, 0
  s_add_u32 s97, s97, s68
  s_add_u32 s97, s97, s66
  s_cmp_lt_u32 s67, 6
  s_cselect_b32 s94, 1, 0
  s_cmp_ge_u32 s54, 4
  s_cbranch_scc1 L_p1_nopf
  s_cmp_lg_u32 s52, 1
  s_cbranch_scc1 L_p1_nopf
  s_lshl_b32 s66, s55, 4
  v_lshrrev_b32 v3, 2, v1
  v_add_u32 v3, s66, v3
  v_mul_u32_u24 v3, 6144, v3
  v_and_b32 v2, 3, v1
  v_lshl_add_u32 v3, v2, 7, v3
  s_lshl_b32 s66, s54, 9
  buffer_load_dword v13, v3, s[28:31], s66 offen
L_p1_nopf:
  v_lshlrev_b32 v3, 1, v0
  buffer_load_ushort v14, v3, s[32:35], 0 offen
  s_cmp_lt_u32 s62, 64
  s_cbranch_scc1 L_p1a
L_p1_back:
  s_lshl_b32 s66, s56, 7
  s_lshl_b32 s67, s64, 5
  s_add_u32 s66, s66, s67
  v_lshrrev_b32 v4, 3, v1
  v_add_u32 v4, s66, v4
  v_lshlrev_b32 v4, 10, v4
  v_and_b32 v5, 7, v1
  v_lshl_add_u32 v4, v5, 4, v4
  s_lshl_b32 s67, s63, 9
  v_add_u32 v4, s67, v4
  s_add_u32 s66, s96, 0
  s_and_b32 s66, s66, 3
  s_lshl_b32 s66, s66, 7
  v_add_u32 v252, s66, v4
  s_add_u32 s66, s96, 1
  s_and_b32 s66, s66, 3
  s_lshl_b32 s66, s66, 7
  v_add_u32 v253, s66, v4
  s_add_u32 s66, s96, 2
  s_and_b32 s66, s66, 3
  s_lshl_b32 s66, s66, 7
  v_add_u32 v254, s66, v4
  s_add_u32 s66, s96, 3
  s_and_b32 s66, s66, 3
  s_lshl_b32 s66, s66, 7
  v_add_u32 v255, s66, v4
  s_setprio 3
  buffer_load_dwordx4 v[32:35], v252, s[8:11], 0 offen
  buffer_load_dwordx4 v[36:39], v252, s[8:11], s86 offen
  buffer_load_dwordx4 v[40:43], v252, s[8:11], s87 offen
  buffer_load_dwordx4 v[44:47], v252, s[8:11], s88 offen
  s_setprio 2
  buffer_load_dwordx4 v[64:67], v253, s[8:11], 0 offen
  buffer_load_dwordx4 v[68:71], v253, s[8:11], s86 offen
  buffer_load_dwordx4 v[72:75], v253, s[8:11], s87 offen
  buffer_load_dwordx4 v[76:79], v253, s[8:11], s88 offen
  s_setprio 0
L_x_issued:
  v_lshrrev_b32 v2, 2, v1
  v_mul_u32_u24 v2, 3072, v2
  v_and_b32 v3, 3, v1
  v_lshl_add_u32 v2, v3, 4, v2
  s_waitcnt lgkmcnt(0)
  s_mul_i32 s53, s65, 1664525
  s_add_u32 s53, s53, 1013904223
  s_lshl_b32 s66, s52, 12
  s_add_u32 s66, s66, 98304
  v_lshrrev_b32 v10, 3, v1
  v_and_b32 v11, 7, v1
  v_lshrrev_b32 v12, 1, v10
  v_xor_b32 v11, v11, v12
  v_lshlrev_b32 v4, 7, v10
  v_lshl_add_u32 v4, v11, 4, v4
  v_add_u32 v4, s66, v4
  v_xor_b32 v5, 64, v4
  v_and_b32 v10, 31, v1
  v_lshrrev_b32 v11, 5, v1
  v_bfe_u32 v12, v10, 1, 3
  v_xor_b32 v11, v11, v12
  v_lshlrev_b32 v10, 7, v10
  v_add_u32 v10, s66, v10
  v_lshl_add_u32 v6, v11, 4, v10
  v_xor_b32 v7, 32, v6
  v_xor_b32 v8, 64, v6
  v_xor_b32 v9, 96, v6
  v_lshrrev_b32 v13, 2, v1
  v_lshlrev_b32 v13, 7, v13
  v_and_b32 v10, 3, v1
  v_lshl_add_u32 v13, v10, 4, v13
  v_add_u32 v13, 4096, v13
  v_mov_b32 v248, 0x3f803f80
  v_mov_b32 v244, 0
  v_mov_b32 v245, 0
  v_mov_b32 v246, 0
  v_mov_b32 v247, 0
  s_cmp_eq_u32 s98, 1
  s_cbranch_scc1 L_xp_1
  s_waitcnt vmcnt(4)
  s_branch L_xp_2
L_xp_1:
  s_waitcnt vmcnt(12)
L_xp_2:
  ds_write_b128 v4, v[32:35] offset:0
  ds_write_b128 v5, v[36:39] offset:1024
  ds_write_b128 v4, v[40:43] offset:2048
  ds_write_b128 v5, v[44:47] offset:3072
  ds_read_b128 v[32:35], v6
  ds_read_b128 v[36:39], v7
  ds_read_b128 v[40:43], v8
  ds_read_b128 v[44:47], v9
  s_cmp_eq_u32 s98, 1
  s_cbranch_scc1 L_xp_3
  buffer_load_dwordx4 v[96:99], v254, s[8:11], 0 offen
  buffer_load_dwordx4 v[100:103], v254, s[8:11], s86 offen
  buffer_load_dwordx4 v[104:107], v254, s[8:11], s87 offen
  buffer_load_dwordx4 v[108:111], v254, s[8:11], s88 offen
L_xp_3:
  s_cmp_eq_u32 s98, 1
  s_cbranch_scc1 L_xp_4
  s_waitcnt vmcnt(4)
  s_branch L_xp_5
L_xp_4:
  s_waitcnt vmcnt(8)
L_xp_5:
  ds_write_b128 v4, v[64:67] offset:0
  ds_write_b128 v5, v[68:71] offset:1024
  ds_write_b128 v4, v[72:75] offset:2048
  ds_write_b128 v5, v[76:79] offset:3072
  ds_read_b128 v[64:67], v6
  ds_read_b128 v[68:71], v7
  ds_read_b128 v[72:75], v8
  ds_read_b128 v[76:79], v9
  s_cmp_eq_u32 s98, 1
  s_cbranch_scc1 L_xp_6
  buffer_load_dwordx4 v[128:131], v255, s[8:11], 0 offen
  buffer_load_dwordx4 v[132:135], v255, s[8:11], s86 offen
  buffer_load_dwordx4 v[136:139], v255, s[8:11], s87 offen
  buffer_load_dwordx4 v[140:143], v255, s[8:11], s88 offen
L_xp_6:
  s_waitcnt lgkmcnt(8)
  v_dot2_f32_bf16 v244, v32, v248, v244
  v_dot2_f32_bf16 v246, v32, v32, v246
  v_dot2_f32_bf16 v245, v33, v248, v245
  v_dot2_f32_bf16 v247, v33, v33, v247
  v_dot2_f32_bf16 v244, v34, v248, v244
  v_dot2_f32_bf16 v246, v34, v34, v246
  v_dot2_f32_bf16 v245, v35, v248, v245
  v_dot2_f32_bf16 v247, v35, v35, v247
  s_cmp_eq_u32 s94, 0
  s_cbranch_scc1 L_w1_7
  s_add_u32 s93, s96, 0
  s_and_b32 s93, s93, 3
  s_mul_i32 s93, s93, 196608
  s_add_u32 s93, s93, s97
  s_mov_b32 m0, s92
  s_add_u32 s92, s92, 1024
  buffer_load_dwordx4 v2, s[12:15], s93 offen lds
  s_add_u32 s93, s93, 49152
L_w1_7:
  v_dot2_f32_bf16 v244, v36, v248, v244
  v_dot2_f32_bf16 v246, v36, v36, v246
  v_dot2_f32_bf16 v245, v37, v248, v245
  v_dot2_f32_bf16 v247, v37, v37, v247
  v_dot2_f32_bf16 v244, v38, v248, v244
  v_dot2_f32_bf16 v246, v38, v38, v246
  v_dot2_f32_bf16 v245, v39, v248, v245
  v_dot2_f32_bf16 v247, v39, v39, v247
  v_dot2_f32_bf16 v244, v40, v248, v244
  v_dot2_f32_bf16 v246, v40, v40, v246
  v_dot2_f32_bf16 v245, v41, v248, v245
  v_dot2_f32_bf16 v247, v41, v41, v247
  v_dot2_f32_bf16 v244, v42, v248, v244
  v_dot2_f32_bf16 v246, v42, v42, v246
  v_dot2_f32_bf16 v245, v43, v248, v245
  v_dot2_f32_bf16 v247, v43, v43, v247
  s_cmp_eq_u32 s94, 0
  s_cbranch_scc1 L_w1_8
  s_mov_b32 m0, s92
  s_add_u32 s92, s92, 1024
  buffer_load_dwordx4 v2, s[12:15], s93 offen lds
  s_add_u32 s93, s93, 49152
L_w1_8:
  v_dot2_f32_bf16 v244, v44, v248, v244
  v_dot2_f32_bf16 v246, v44, v44, v246
  v_dot2_f32_bf16 v245, v45, v248, v245
  v_dot2_f32_bf16 v247, v45, v45, v247
  v_dot2_f32_bf16 v244, v46, v248, v244
  v_dot2_f32_bf16 v246, v46, v46, v246
  v_dot2_f32_bf16 v245, v47, v248, v245
  v_dot2_f32_bf16 v247, v47, v47, v247
  v_lshlrev_b32 v16, 16, v32
  v_and_b32 v17, s80, v32
  v_lshlrev_b32 v18, 16, v33
  v_and_b32 v19, s80, v33
  v_lshlrev_b32 v20, 16, v34
  v_and_b32 v21, s80, v34
  v_lshlrev_b32 v22, 16, v35
  v_and_b32 v23, s80, v35
  s_cmp_eq_u32 s94, 0
  s_cbranch_scc1 L_w1_9
  s_mov_b32 m0, s92
  s_add_u32 s92, s92, 1024
  buffer_load_dwordx4 v2, s[12:15], s93 offen lds
  s_add_u32 s93, s93, 49152
L_w1_9:
  v_lshlrev_b32 v24, 16, v36
  v_and_b32 v25, s80, v36
  v_lshlrev_b32 v26, 16, v37
  v_and_b32 v27, s80, v37
  v_lshlrev_b32 v28, 16, v38
  v_and_b32 v29, s80, v38
  v_lshlrev_b32 v30, 16, v39
  v_and_b32 v31, s80, v39
  v_lshlrev_b32 v32, 16, v40
  v_and_b32 v33, s80, v40
  v_lshlrev_b32 v34, 16, v41
  v_and_b32 v35, s80, v41
  v_lshlrev_b32 v36, 16, v42
  v_and_b32 v37, s80, v42
  v_lshlrev_b32 v38, 16, v43
  v_and_b32 v39, s80, v43
  s_cmp_eq_u32 s94, 0
  s_cbranch_scc1 L_w1_10
  s_mov_b32 m0, s92
  s_add_u32 s92, s92, 1024
  buffer_load_dwordx4 v2, s[12:15], s93 offen lds
  s_add_u32 s93, s93, 49152
L_w1_10:
  v_lshlrev_b32 v40, 16, v44
  v_and_b32 v41, s80, v44
  v_lshlrev_b32 v42, 16, v45
  v_and_b32 v43, s80, v45
  v_lshlrev_b32 v44, 16, v46
  v_and_b32 v45, s80, v46
  v_lshlrev_b32 v46, 16, v47
  v_and_b32 v47, s80, v47
  s_cmp_eq_u32 s98, 1
  s_cbranch_scc1 L_xp_11
  s_cmp_eq_u32 s94, 0
  s_cbranch_scc1 L_vw_13
  s_waitcnt vmcnt(8)
  s_branch L_vw_14
L_vw_13:
  s_waitcnt vmcnt(4)
L_vw_14:
  s_branch L_xp_12
L_xp_11:
  s_waitcnt vmcnt(4)
L_xp_12:
  ds_write_b128 v4, v[96:99] offset:0
  ds_write_b128 v5, v[100:103] offset:1024
  ds_write_b128 v4, v[104:107] offset:2048
  ds_write_b128 v5, v[108:111] offset:3072
  ds_read_b128 v[96:99], v6
  ds_read_b128 v[100:103], v7
  ds_read_b128 v[104:107], v8
  ds_read_b128 v[108:111], v9
  s_waitcnt lgkmcnt(8)
  v_dot2_f32_bf16 v244, v64, v248, v244
  v_dot2_f32_bf16 v246, v64, v64, v246
  v_dot2_f32_bf16 v245, v65, v248, v245
  v_dot2_f32_bf16 v247, v65, v65, v247
  v_dot2_f32_bf16 v244, v66, v248, v244
  v_dot2_f32_bf16 v246, v66, v66, v246
  v_dot2_f32_bf16 v245, v67, v248, v245
  v_dot2_f32_bf16 v247, v67, v67, v247
  v_dot2_f32_bf16 v244, v68, v248, v244
  v_dot2_f32_bf16 v246, v68, v68, v246
  v_dot2_f32_bf16 v245, v69, v248, v245
  v_dot2_f32_bf16 v247, v69, v69, v247
  v_dot2_f32_bf16 v244, v70, v248, v244
  v_dot2_f32_bf16 v246, v70, v70, v246
  v_dot2_f32_bf16 v245, v71, v248, v245
  v_dot2_f32_bf16 v247, v71, v71, v247
  v_dot2_f32_bf16 v244, v72, v248, v244
  v_dot2_f32_bf16 v246, v72, v72, v246
  v_dot2_f32_bf16 v245, v73, v248, v245
  v_dot2_f32_bf16 v247, v73, v73, v247
  v_dot2_f32_bf16 v244, v74, v248, v244
  v_dot2_f32_bf16 v246, v74, v74, v246
  v_dot2_f32_bf16 v245, v75, v248, v245
  v_dot2_f32_bf16 v247, v75, v75, v247
  v_dot2_f32_bf16 v244, v76, v248, v244
  v_dot2_f32_bf16 v246, v76, v76, v246
  v_dot2_f32_bf16 v245, v77, v248, v245
  v_dot2_f32_bf16 v247, v77, v77, v247
  v_dot2_f32_bf16 v244, v78, v248, v244
  v_dot2_f32_bf16 v246, v78, v78, v246
  v_dot2_f32_bf16 v245, v79, v248, v245
  v_dot2_f32_bf16 v247, v79, v79, v247
  v_lshlrev_b32 v48, 16, v64
  v_and_b32 v49, s80, v64
  v_lshlrev_b32 v50, 16, v65
  v_and_b32 v51, s80, v65
  v_lshlrev_b32 v52, 16, v66
  v_and_b32 v53, s80, v66
  v_lshlrev_b32 v54, 16, v67
  v_and_b32 v55, s80, v67
  v_lshlrev_b32 v56, 16, v68
  v_and_b32 v57, s80, v68
  v_lshlrev_b32 v58, 16, v69
  v_and_b32 v59, s80, v69
  v_lshlrev_b32 v60, 16, v70
  v_and_b32 v61, s80, v70
  v_lshlrev_b32 v62, 16, v71
  v_and_b32 v63, s80, v71
  v_lshlrev_b32 v64, 16, v72
  v_and_b32 v65, s80, v72
  v_lshlrev_b32 v66, 16, v73
  v_and_b32 v67, s80, v73
  v_lshlrev_b32 v68, 16, v74
  v_and_b32 v69, s80, v74
  v_lshlrev_b32 v70, 16, v75
  v_and_b32 v71, s80, v75
  v_lshlrev_b32 v72, 16, v76
  v_and_b32 v73, s80, v76
  v_lshlrev_b32 v74, 16, v77
  v_and_b32 v75, s80, v77
  v_lshlrev_b32 v76, 16, v78
  v_and_b32 v77, s80, v78
  v_lshlrev_b32 v78, 16, v79
  v_and_b32 v79, s80, v79
  s_cmp_eq_u32 s98, 1
  s_cbranch_scc1 L_xp_15
  s_cmp_eq_u32 s94, 0
  s_cbranch_scc1 L_vw_17
  s_waitcnt vmcnt(4)
  s_branch L_vw_18
L_vw_17:
  s_waitcnt vmcnt(0)
L_vw_18:
  s_branch L_xp_16
L_xp_15:
  s_waitcnt vmcnt(0)
L_xp_16:
  ds_write_b128 v4, v[128:131] offset:0
  ds_write_b128 v5, v[132:135] offset:1024
  ds_write_b128 v4, v[136:139] offset:2048
  ds_write_b128 v5, v[140:143] offset:3072
  ds_read_b128 v[128:131], v6
  ds_read_b128 v[132:135], v7
  ds_read_b128 v[136:139], v8
  ds_read_b128 v[140:143], v9
  s_cmp_lg_u32 s52, 0
  s_cbranch_scc1 L_xw_19
  s_setprio 3
  s_mov_b32 s66, 4096
  buffer_load_dwordx4 v[144:147], v13, s[20:23], 0 offen offset:0 sc1
  buffer_load_dwordx4 v[148:151], v13, s[20:23], 0 offen offset:2048 sc1
  buffer_load_dwordx4 v[152:155], v13, s[20:23], s66 offen offset:0 sc1
  buffer_load_dwordx4 v[156:159], v13, s[20:23], s66 offen offset:2048 sc1
  s_setprio 0
L_xw_19:
  s_waitcnt lgkmcnt(8)
  v_dot2_f32_bf16 v244, v96, v248, v244
  v_dot2_f32_bf16 v246, v96, v96, v246
  v_dot2_f32_bf16 v245, v97, v248, v245
  v_dot2_f32_bf16 v247, v97, v97, v247
  v_dot2_f32_bf16 v244, v98, v248, v244
  v_dot2_f32_bf16 v246, v98, v98, v246
  v_dot2_f32_bf16 v245, v99, v248, v245
  v_dot2_f32_bf16 v247, v99, v99, v247
  v_dot2_f32_bf16 v244, v100, v248, v244
  v_dot2_f32_bf16 v246, v100, v100, v246
  v_dot2_f32_bf16 v245, v101, v248, v245
  v_dot2_f32_bf16 v247, v101, v101, v247
  v_dot2_f32_bf16 v244, v102, v248, v244
  v_dot2_f32_bf16 v246, v102, v102, v246
  v_dot2_f32_bf16 v245, v103, v248, v245
  v_dot2_f32_bf16 v247, v103, v103, v247
  v_dot2_f32_bf16 v244, v104, v248, v244
  v_dot2_f32_bf16 v246, v104, v104, v246
  v_dot2_f32_bf16 v245, v105, v248, v245
  v_dot2_f32_bf16 v247, v105, v105, v247
  v_dot2_f32_bf16 v244, v106, v248, v244
  v_dot2_f32_bf16 v246, v106, v106, v246
  v_dot2_f32_bf16 v245, v107, v248, v245
  v_dot2_f32_bf16 v247, v107, v107, v247
  v_dot2_f32_bf16 v244, v108, v248, v244
  v_dot2_f32_bf16 v246, v108, v108, v246
  v_dot2_f32_bf16 v245, v109, v248, v245
  v_dot2_f32_bf16 v247, v109, v109, v247
  v_dot2_f32_bf16 v244, v110, v248, v244
  v_dot2_f32_bf16 v246, v110, v110, v246
  v_dot2_f32_bf16 v245, v111, v248, v245
  v_dot2_f32_bf16 v247, v111, v111, v247
  v_lshlrev_b32 v80, 16, v96
  v_and_b32 v81, s80, v96
  v_lshlrev_b32 v82, 16, v97
  v_and_b32 v83, s80, v97
  v_lshlrev_b32 v84, 16, v98
  v_and_b32 v85, s80, v98
  v_lshlrev_b32 v86, 16, v99
  v_and_b32 v87, s80, v99
  v_lshlrev_b32 v88, 16, v100
  v_and_b32 v89, s80, v100
  v_lshlrev_b32 v90, 16, v101
  v_and_b32 v91, s80, v101
  v_lshlrev_b32 v92, 16, v102
  v_and_b32 v93, s80, v102
  v_lshlrev_b32 v94, 16, v103
  v_and_b32 v95, s80, v103
  v_lshlrev_b32 v96, 16, v104
  v_and_b32 v97, s80, v104
  v_lshlrev_b32 v98, 16, v105
  v_and_b32 v99, s80, v105
  v_lshlrev_b32 v100, 16, v106
  v_and_b32 v101, s80, v106
  v_lshlrev_b32 v102, 16, v107
  v_and_b32 v103, s80, v107
  v_lshlrev_b32 v104, 16, v108
  v_and_b32 v105, s80, v108
  v_lshlrev_b32 v106, 16, v109
  v_and_b32 v107, s80, v109
  v_lshlrev_b32 v108, 16, v110
  v_and_b32 v109, s80, v110
  v_lshlrev_b32 v110, 16, v111
  v_and_b32 v111, s80, v111
  s_waitcnt lgkmcnt(0)
  v_dot2_f32_bf16 v244, v128, v248, v244
  v_dot2_f32_bf16 v246, v128, v128, v246
  v_dot2_f32_bf16 v245, v129, v248, v245
  v_dot2_f32_bf16 v247, v129, v129, v247
  v_dot2_f32_bf16 v244, v130, v248, v244
  v_dot2_f32_bf16 v246, v130, v130, v246
  v_dot2_f32_bf16 v245, v131, v248, v245
  v_dot2_f32_bf16 v247, v131, v131, v247
  v_dot2_f32_bf16 v244, v132, v248, v244
  v_dot2_f32_bf16 v246, v132, v132, v246
  v_dot2_f32_bf16 v245, v133, v248, v245
  v_dot2_f32_bf16 v247, v133, v133, v247
  v_dot2_f32_bf16 v244, v134, v248, v244
  v_dot2_f32_bf16 v246, v134, v134, v246
  v_dot2_f32_bf16 v245, v135, v248, v245
  v_dot2_f32_bf16 v247, v135, v135, v247
  v_dot2_f32_bf16 v244, v136, v248, v244
  v_dot2_f32_bf16 v246, v136, v136, v246
  v_dot2_f32_bf16 v245, v137, v248, v245
  v_dot2_f32_bf16 v247, v137, v137, v247
  v_dot2_f32_bf16 v244, v138, v248, v244
  v_dot2_f32_bf16 v246, v138, v138, v246
  v_dot2_f32_bf16 v245, v139, v248, v245
  v_dot2_f32_bf16 v247, v139, v139, v247
  v_dot2_f32_bf16 v244, v140, v248, v244
  v_dot2_f32_bf16 v246, v140, v140, v246
  v_dot2_f32_bf16 v245, v141, v248, v245
  v_dot2_f32_bf16 v247, v141, v141, v247
  v_dot2_f32_bf16 v244, v142, v248, v244
  v_dot2_f32_bf16 v246, v142, v142, v246
  v_dot2_f32_bf16 v245, v143, v248, v245
  v_dot2_f32_bf16 v247, v143, v143, v247
  s_nop 1
  v_add_f32 v244, v244, v245
  v_add_f32 v246, v246, v247
  v_mov_b32 v245, v244
  v_mov_b32 v247, v246
  s_nop 0
  v_permlane32_swap_b32 v244, v245
  v_permlane32_swap_b32 v246, v247
  v_add_f32 v244, v244, v245
  v_add_f32 v245, v246, v247
  s_lshl_b32 s66, s64, 9
  s_lshl_b32 s67, s63, 8
  s_add_u32 s66, s66, s67
  s_add_u32 s66, s66, 152576
  v_and_b32 v10, 31, v1
  v_lshl_add_u32 v10, v10, 3, s66
  ds_write_b64 v10, v[244:245]
  v_lshlrev_b32 v112, 16, v128
  v_and_b32 v113, s80, v128
  v_lshlrev_b32 v114, 16, v129
  v_and_b32 v115, s80, v129
  v_lshlrev_b32 v116, 16, v130
  v_and_b32 v117, s80, v130
  v_lshlrev_b32 v118, 16, v131
  v_and_b32 v119, s80, v131
  v_lshlrev_b32 v120, 16, v132
  v_and_b32 v121, s80, v132
  v_lshlrev_b32 v122, 16, v133
  v_and_b32 v123, s80, v133
  v_lshlrev_b32 v124, 16, v134
  v_and_b32 v125, s80, v134
  v_lshlrev_b32 v126, 16, v135
  v_and_b32 v127, s80, v135
  v_lshlrev_b32 v128, 16, v136
  v_and_b32 v129, s80, v136
  v_lshlrev_b32 v130, 16, v137
  v_and_b32 v131, s80, v137
  v_lshlrev_b32 v132, 16, v138
  v_and_b32 v133, s80, v138
  v_lshlrev_b32 v134, 16, v139
  v_and_b32 v135, s80, v139
  v_lshlrev_b32 v136, 16, v140
  v_and_b32 v137, s80, v140
  v_lshlrev_b32 v138, 16, v141
  v_and_b32 v139, s80, v141
  v_lshlrev_b32 v140, 16, v142
  v_and_b32 v141, s80, v142
  v_lshlrev_b32 v142, 16, v143
  v_and_b32 v143, s80, v143
  s_cmp_lg_u32 s52, 0
  s_cbranch_scc1 L_mps_23
  s_lshl_b32 s70, s96, 6
  v_lshlrev_b32 v10, 2, v1
  v_subrev_u32 v10, s70, v10
  v_and_b32 v10, 255, v10
  v_bfe_u32 v240, v10, 3, 1
  v_lshlrev_b32 v242, 9, v240
  v_bfe_u32 v240, v10, 4, 1
  v_lshl_add_u32 v242, v240, 8, v242
  v_and_b32 v240, 7, v10
  v_lshl_add_u32 v242, v240, 5, v242
  v_lshrrev_b32 v240, 5, v10
  v_lshl_add_u32 v242, v240, 2, v242
  v_add_u32 v242, 147456, v242
  v_lshlrev_b32 v10, 2, v10
  v_add_u32 v10, 149504, v10
  s_setprio 3
  s_mov_b32 s66, 4096
  buffer_load_dwordx4 v[160:163], v13, s[20:23], 0 offen offset:0 sc1
  buffer_load_dwordx4 v[164:167], v13, s[20:23], 0 offen offset:2048 sc1
  buffer_load_dwordx4 v[168:171], v13, s[20:23], s66 offen offset:0 sc1
  buffer_load_dwordx4 v[172:175], v13, s[20:23], s66 offen offset:2048 sc1
L_mp_20:
  s_waitcnt vmcnt(4)
  v_cmp_eq_u32 vcc, s53, v145
  v_cmp_eq_u32 s[68:69], s53, v147
  s_nop 0
  s_and_b64 vcc, vcc, s[68:69]
  v_cmp_eq_u32 s[68:69], s53, v149
  s_nop 0
  s_and_b64 vcc, vcc, s[68:69]
  v_cmp_eq_u32 s[68:69], s53, v151
  s_nop 0
  s_and_b64 vcc, vcc, s[68:69]
  v_cmp_eq_u32 s[68:69], s53, v153
  s_nop 0
  s_and_b64 vcc, vcc, s[68:69]
  v_cmp_eq_u32 s[68:69], s53, v155
  s_nop 0
  s_and_b64 vcc, vcc, s[68:69]
  v_cmp_eq_u32 s[68:69], s53, v157
  s_nop 0
  s_and_b64 vcc, vcc, s[68:69]
  v_cmp_eq_u32 s[68:69], s53, v159
  s_nop 0
  s_and_b64 vcc, vcc, s[68:69]
  s_cmp_eq_u64 vcc, exec
  s_cbranch_scc1 L_mpg_24
  s_mov_b32 s66, 4096
  buffer_load_dwordx4 v[144:147], v13, s[20:23], 0 offen offset:0 sc1
  buffer_load_dwordx4 v[148:151], v13, s[20:23], 0 offen offset:2048 sc1
  buffer_load_dwordx4 v[152:155], v13, s[20:23], s66 offen offset:0 sc1
  buffer_load_dwordx4 v[156:159], v13, s[20:23], s66 offen offset:2048 sc1
  s_waitcnt vmcnt(4)
  v_cmp_eq_u32 vcc, s53, v161
  v_cmp_eq_u32 s[68:69], s53, v163
  s_nop 0
  s_and_b64 vcc, vcc, s[68:69]
  v_cmp_eq_u32 s[68:69], s53, v165
  s_nop 0
  s_and_b64 vcc, vcc, s[68:69]
  v_cmp_eq_u32 s[68:69], s53, v167
  s_nop 0
  s_and_b64 vcc, vcc, s[68:69]
  v_cmp_eq_u32 s[68:69], s53, v169
  s_nop 0
  s_and_b64 vcc, vcc, s[68:69]
  v_cmp_eq_u32 s[68:69], s53, v171
  s_nop 0
  s_and_b64 vcc, vcc, s[68:69]
  v_cmp_eq_u32 s[68:69], s53, v173
  s_nop 0
  s_and_b64 vcc, vcc, s[68:69]
  v_cmp_eq_u32 s[68:69], s53, v175
  s_nop 0
  s_and_b64 vcc, vcc, s[68:69]
  s_cmp_eq_u64 vcc, exec
  s_cbranch_scc1 L_mpg_25
  s_cmp_eq_u32 s81, 0
  s_cbranch_scc1 L_mpg_25
  s_sub_u32 s81, s81, 1
  s_mov_b32 s66, 4096
  buffer_load_dwordx4 v[160:163], v13, s[20:23], 0 offen offset:0 sc1
  buffer_load_dwordx4 v[164:167], v13, s[20:23], 0 offen offset:2048 sc1
  buffer_load_dwordx4 v[168:171], v13, s[20:23], s66 offen offset:0 sc1
  buffer_load_dwordx4 v[172:175], v13, s[20:23], s66 offen offset:2048 sc1
  s_branch L_mp_20
L_mpg_24:
  v_and_b32 v145, s80, v144
  v_lshlrev_b32 v144, 16, v144
  v_and_b32 v147, s80, v146
  v_lshlrev_b32 v146, 16, v146
  ds_write_b128 v10, v[144:147] offset:0
  v_and_b32 v149, s80, v148
  v_lshlrev_b32 v148, 16, v148
  v_and_b32 v151, s80, v150
  v_lshlrev_b32 v150, 16, v150
  ds_write_b128 v10, v[148:151] offset:1024
  v_and_b32 v153, s80, v152
  v_lshlrev_b32 v152, 16, v152
  v_and_b32 v155, s80, v154
  v_lshlrev_b32 v154, 16, v154
  ds_write_b32 v242, v152 offset:0
  ds_write_b32 v242, v153 offset:32
  ds_write_b32 v242, v154 offset:64
  ds_write_b32 v242, v155 offset:96
  v_and_b32 v157, s80, v156
  v_lshlrev_b32 v156, 16, v156
  v_and_b32 v159, s80, v158
  v_lshlrev_b32 v158, 16, v158
  ds_write_b32 v242, v156 offset:1024
  ds_write_b32 v242, v157 offset:1056
  ds_write_b32 v242, v158 offset:1088
  ds_write_b32 v242, v159 offset:1120
  s_branch L_mpd_22
L_mpg_25:
  v_and_b32 v161, s80, v160
  v_lshlrev_b32 v160, 16, v160
  v_and_b32 v163, s80, v162
  v_lshlrev_b32 v162, 16, v162
  ds_write_b128 v10, v[160:163] offset:0
  v_and_b32 v165, s80, v164
  v_lshlrev_b32 v164, 16, v164
  v_and_b32 v167, s80, v166
  v_lshlrev_b32 v166, 16, v166
  ds_write_b128 v10, v[164:167] offset:1024
  v_and_b32 v169, s80, v168
  v_lshlrev_b32 v168, 16, v168
  v_and_b32 v171, s80, v170
  v_lshlrev_b32 v170, 16, v170
  ds_write_b32 v242, v168 offset:0
  ds_write_b32 v242, v169 offset:32
  ds_write_b32 v242, v170 offset:64
  ds_write_b32 v242, v171 offset:96
  v_and_b32 v173, s80, v172
  v_lshlrev_b32 v172, 16, v172
  v_and_b32 v175, s80, v174
  v_lshlrev_b32 v174, 16, v174
  ds_write_b32 v242, v172 offset:1024
  ds_write_b32 v242, v173 offset:1056
  ds_write_b32 v242, v174 offset:1088
  ds_write_b32 v242, v175 offset:1120
L_mpd_22:
  s_setprio 0
L_mps_23:
  s_waitcnt vmcnt(0) lgkmcnt(0)
  s_barrier
  s_lshl_b32 s66, s64, 9
  s_add_u32 s66, s66, 152576
  v_and_b32 v10, 31, v1
  v_lshl_add_u32 v10, v10, 3, s66
  ds_read_b64 v[244:245], v10
  ds_read_b64 v[246:247], v10 offset:256
  s_lshl_b32 s66, s63, 10
  s_add_u32 s66, s66, 147456
  v_lshrrev_b32 v11, 5, v1
  v_lshl_add_u32 v12, v11, 5, s66
  v_and_b32 v8, 15, v1
  v_lshlrev_b32 v8, 5, v8
  v_lshl_add_u32 v8, v11, 9, v8
  v_add_u32 v8, s66, v8
  ds_read_b128 v[192:195], v8
  ds_read_b128 v[196:199], v8 offset:16
  ds_read_b128 v[224:227], v12 offset:2048
  ds_read_b128 v[228:231], v12 offset:2064
  s_mul_i32 s66, s63, 49152
  v_lshlrev_b32 v7, 9, v11
  v_bfe_u32 v8, v1, 2, 2
  v_lshl_add_u32 v7, v8, 6, v7
  v_bfe_u32 v8, v1, 4, 1
  v_lshl_add_u32 v7, v8, 5, v7
  v_and_b32 v8, 3, v1
  v_lshl_add_u32 v7, v8, 3, v7
  v_add_u32 v13, s66, v7
  s_waitcnt lgkmcnt(4)
  v_add_f32 v244, v244, v246
  v_add_f32 v245, v245, v247
  v_mul_f32 v10, 0x3b000000, v244
  v_mul_f32 v11, 0x3b000000, v245
  v_fma_f32 v11, -v10, v10, v11
  v_max_f32 v11, 0, v11
  v_cvt_pk_bf16_f32 v10, v10, v10
  v_lshlrev_b32 v10, 16, v10
  v_cvt_pk_bf16_f32 v11, v11, v11
  v_lshlrev_b32 v11, 16, v11
  v_add_f32 v11, 0x3727c5ac, v11
  v_cvt_pk_bf16_f32 v11, v11, v11
  v_lshlrev_b32 v11, 16, v11
  v_sqrt_f32 v11, v11
  s_nop 0
  v_cvt_pk_bf16_f32 v11, v11, v11
  v_lshlrev_b32 v11, 16, v11
  v_rcp_f32 v250, v11
  s_nop 0
  v_mul_f32 v251, v10, v250
  v_sub_f32 v251, 0, v251
  v_pk_fma_f32 v[16:17], v[16:17], v[250:251], v[250:251] op_sel:[0,0,1] op_sel_hi:[1,0,1]
  v_pk_fma_f32 v[18:19], v[18:19], v[250:251], v[250:251] op_sel:[0,0,1] op_sel_hi:[1,0,1]
  v_pk_fma_f32 v[20:21], v[20:21], v[250:251], v[250:251] op_sel:[0,0,1] op_sel_hi:[1,0,1]
  v_pk_fma_f32 v[22:23], v[22:23], v[250:251], v[250:251] op_sel:[0,0,1] op_sel_hi:[1,0,1]
  s_cmp_eq_u32 s94, 0
  s_cbranch_scc1 L_w1_26
  s_add_u32 s93, s96, 1
  s_and_b32 s93, s93, 3
  s_mul_i32 s93, s93, 196608
  s_add_u32 s93, s93, s97
  s_mov_b32 m0, s92
  s_add_u32 s92, s92, 1024
  buffer_load_dwordx4 v2, s[12:15], s93 offen lds
  s_add_u32 s93, s93, 49152
L_w1_26:
  v_pk_fma_f32 v[24:25], v[24:25], v[250:251], v[250:251] op_sel:[0,0,1] op_sel_hi:[1,0,1]
  v_pk_fma_f32 v[26:27], v[26:27], v[250:251], v[250:251] op_sel:[0,0,1] op_sel_hi:[1,0,1]
  v_pk_fma_f32 v[28:29], v[28:29], v[250:251], v[250:251] op_sel:[0,0,1] op_sel_hi:[1,0,1]
  v_pk_fma_f32 v[30:31], v[30:31], v[250:251], v[250:251] op_sel:[0,0,1] op_sel_hi:[1,0,1]
  v_pk_fma_f32 v[32:33], v[32:33], v[250:251], v[250:251] op_sel:[0,0,1] op_sel_hi:[1,0,1]
  v_pk_fma_f32 v[34:35], v[34:35], v[250:251], v[250:251] op_sel:[0,0,1] op_sel_hi:[1,0,1]
  v_pk_fma_f32 v[36:37], v[36:37], v[250:251], v[250:251] op_sel:[0,0,1] op_sel_hi:[1,0,1]
  v_pk_fma_f32 v[38:39], v[38:39], v[250:251], v[250:251] op_sel:[0,0,1] op_sel_hi:[1,0,1]
  s_cmp_eq_u32 s94, 0
  s_cbranch_scc1 L_w1_27
  s_mov_b32 m0, s92
  s_add_u32 s92, s92, 1024
  buffer_load_dwordx4 v2, s[12:15], s93 offen lds
  s_add_u32 s93, s93, 49152
L_w1_27:
  v_pk_fma_f32 v[40:41], v[40:41], v[250:251], v[250:251] op_sel:[0,0,1] op_sel_hi:[1,0,1]
  v_pk_fma_f32 v[42:43], v[42:43], v[250:251], v[250:251] op_sel:[0,0,1] op_sel_hi:[1,0,1]
  v_pk_fma_f32 v[44:45], v[44:45], v[250:251], v[250:251] op_sel:[0,0,1] op_sel_hi:[1,0,1]
  v_pk_fma_f32 v[46:47], v[46:47], v[250:251], v[250:251] op_sel:[0,0,1] op_sel_hi:[1,0,1]
  v_pk_fma_f32 v[48:49], v[48:49], v[250:251], v[250:251] op_sel:[0,0,1] op_sel_hi:[1,0,1]
  v_pk_fma_f32 v[50:51], v[50:51], v[250:251], v[250:251] op_sel:[0,0,1] op_sel_hi:[1,0,1]
  v_pk_fma_f32 v[52:53], v[52:53], v[250:251], v[250:251] op_sel:[0,0,1] op_sel_hi:[1,0,1]
  v_pk_fma_f32 v[54:55], v[54:55], v[250:251], v[250:251] op_sel:[0,0,1] op_sel_hi:[1,0,1]
  s_cmp_eq_u32 s94, 0
  s_cbranch_scc1 L_w1_28
  s_mov_b32 m0, s92
  s_add_u32 s92, s92, 1024
  buffer_load_dwordx4 v2, s[12:15], s93 offen lds
  s_add_u32 s93, s93, 49152
L_w1_28:
  v_pk_fma_f32 v[56:57], v[56:57], v[250:251], v[250:251] op_sel:[0,0,1] op_sel_hi:[1,0,1]
  v_pk_fma_f32 v[58:59], v[58:59], v[250:251], v[250:251] op_sel:[0,0,1] op_sel_hi:[1,0,1]
  v_pk_fma_f32 v[60:61], v[60:61], v[250:251], v[250:251] op_sel:[0,0,1] op_sel_hi:[1,0,1]
  v_pk_fma_f32 v[62:63], v[62:63], v[250:251], v[250:251] op_sel:[0,0,1] op_sel_hi:[1,0,1]
  v_pk_fma_f32 v[64:65], v[64:65], v[250:251], v[250:251] op_sel:[0,0,1] op_sel_hi:[1,0,1]
  v_pk_fma_f32 v[66:67], v[66:67], v[250:251], v[250:251] op_sel:[0,0,1] op_sel_hi:[1,0,1]
  v_pk_fma_f32 v[68:69], v[68:69], v[250:251], v[250:251] op_sel:[0,0,1] op_sel_hi:[1,0,1]
  v_pk_fma_f32 v[70:71], v[70:71], v[250:251], v[250:251] op_sel:[0,0,1] op_sel_hi:[1,0,1]
  s_cmp_eq_u32 s94, 0
  s_cbranch_scc1 L_w1_29
  s_mov_b32 m0, s92
  s_add_u32 s92, s92, 1024
  buffer_load_dwordx4 v2, s[12:15], s93 offen lds
  s_add_u32 s93, s93, 49152
L_w1_29:
  v_pk_fma_f32 v[72:73], v[72:73], v[250:251], v[250:251] op_sel:[0,0,1] op_sel_hi:[1,0,1]
  v_pk_fma_f32 v[74:75], v[74:75], v[250:251], v[250:251] op_sel:[0,0,1] op_sel_hi:[1,0,1]
  v_pk_fma_f32 v[76:77], v[76:77], v[250:251], v[250:251] op_sel:[0,0,1] op_sel_hi:[1,0,1]
  v_pk_fma_f32 v[78:79], v[78:79], v[250:251], v[250:251] op_sel:[0,0,1] op_sel_hi:[1,0,1]
  v_pk_fma_f32 v[80:81], v[80:81], v[250:251], v[250:251] op_sel:[0,0,1] op_sel_hi:[1,0,1]
  v_pk_fma_f32 v[82:83], v[82:83], v[250:251], v[250:251] op_sel:[0,0,1] op_sel_hi:[1,0,1]
  v_pk_fma_f32 v[84:85], v[84:85], v[250:251], v[250:251] op_sel:[0,0,1] op_sel_hi:[1,0,1]
  v_pk_fma_f32 v[86:87], v[86:87], v[250:251], v[250:251] op_sel:[0,0,1] op_sel_hi:[1,0,1]
  s_cmp_eq_u32 s94, 0
  s_cbranch_scc1 L_w1_30
  s_add_u32 s93, s96, 2
  s_and_b32 s93, s93, 3
  s_mul_i32 s93, s93, 196608
  s_add_u32 s93, s93, s97
  s_mov_b32 m0, s92
  s_add_u32 s92, s92, 1024
  buffer_load_dwordx4 v2, s[12:15], s93 offen lds
  s_add_u32 s93, s93, 49152
L_w1_30:
  v_pk_fma_f32 v[88:89], v[88:89], v[250:251], v[250:251] op_sel:[0,0,1] op_sel_hi:[1,0,1]
  v_pk_fma_f32 v[90:91], v[90:91], v[250:251], v[250:251] op_sel:[0,0,1] op_sel_hi:[1,0,1]
  v_pk_fma_f32 v[92:93], v[92:93], v[250:251], v[250:251] op_sel:[0,0,1] op_sel_hi:[1,0,1]
  v_pk_fma_f32 v[94:95], v[94:95], v[250:251], v[250:251] op_sel:[0,0,1] op_sel_hi:[1,0,1]
  v_pk_fma_f32 v[96:97], v[96:97], v[250:251], v[250:251] op_sel:[0,0,1] op_sel_hi:[1,0,1]
  v_pk_fma_f32 v[98:99], v[98:99], v[250:251], v[250:251] op_sel:[0,0,1] op_sel_hi:[1,0,1]
  v_pk_fma_f32 v[100:101], v[100:101], v[250:251], v[250:251] op_sel:[0,0,1] op_sel_hi:[1,0,1]
  v_pk_fma_f32 v[102:103], v[102:103], v[250:251], v[250:251] op_sel:[0,0,1] op_sel_hi:[1,0,1]
  s_cmp_eq_u32 s94, 0
  s_cbranch_scc1 L_w1_31
  s_mov_b32 m0, s92
  s_add_u32 s92, s92, 1024
  buffer_load_dwordx4 v2, s[12:15], s93 offen lds
  s_add_u32 s93, s93, 49152
L_w1_31:
  v_pk_fma_f32 v[104:105], v[104:105], v[250:251], v[250:251] op_sel:[0,0,1] op_sel_hi:[1,0,1]
  v_pk_fma_f32 v[106:107], v[106:107], v[250:251], v[250:251] op_sel:[0,0,1] op_sel_hi:[1,0,1]
  v_pk_fma_f32 v[108:109], v[108:109], v[250:251], v[250:251] op_sel:[0,0,1] op_sel_hi:[1,0,1]
  v_pk_fma_f32 v[110:111], v[110:111], v[250:251], v[250:251] op_sel:[0,0,1] op_sel_hi:[1,0,1]
  v_pk_fma_f32 v[112:113], v[112:113], v[250:251], v[250:251] op_sel:[0,0,1] op_sel_hi:[1,0,1]
  v_pk_fma_f32 v[114:115], v[114:115], v[250:251], v[250:251] op_sel:[0,0,1] op_sel_hi:[1,0,1]
  v_pk_fma_f32 v[116:117], v[116:117], v[250:251], v[250:251] op_sel:[0,0,1] op_sel_hi:[1,0,1]
  v_pk_fma_f32 v[118:119], v[118:119], v[250:251], v[250:251] op_sel:[0,0,1] op_sel_hi:[1,0,1]
  s_cmp_eq_u32 s94, 0
  s_cbranch_scc1 L_w1_32
  s_mov_b32 m0, s92
  s_add_u32 s92, s92, 1024
  buffer_load_dwordx4 v2, s[12:15], s93 offen lds
  s_add_u32 s93, s93, 49152
L_w1_32:
  v_pk_fma_f32 v[120:121], v[120:121], v[250:251], v[250:251] op_sel:[0,0,1] op_sel_hi:[1,0,1]
  v_pk_fma_f32 v[122:123], v[122:123], v[250:251], v[250:251] op_sel:[0,0,1] op_sel_hi:[1,0,1]
  v_pk_fma_f32 v[124:125], v[124:125], v[250:251], v[250:251] op_sel:[0,0,1] op_sel_hi:[1,0,1]
  v_pk_fma_f32 v[126:127], v[126:127], v[250:251], v[250:251] op_sel:[0,0,1] op_sel_hi:[1,0,1]
  v_pk_fma_f32 v[128:129], v[128:129], v[250:251], v[250:251] op_sel:[0,0,1] op_sel_hi:[1,0,1]
  v_pk_fma_f32 v[130:131], v[130:131], v[250:251], v[250:251] op_sel:[0,0,1] op_sel_hi:[1,0,1]
  v_pk_fma_f32 v[132:133], v[132:133], v[250:251], v[250:251] op_sel:[0,0,1] op_sel_hi:[1,0,1]
  v_pk_fma_f32 v[134:135], v[134:135], v[250:251], v[250:251] op_sel:[0,0,1] op_sel_hi:[1,0,1]
  s_cmp_eq_u32 s94, 0
  s_cbranch_scc1 L_w1_33
  s_mov_b32 m0, s92
  s_add_u32 s92, s92, 1024
  buffer_load_dwordx4 v2, s[12:15], s93 offen lds
  s_add_u32 s93, s93, 49152
L_w1_33:
  v_pk_fma_f32 v[136:137], v[136:137], v[250:251], v[250:251] op_sel:[0,0,1] op_sel_hi:[1,0,1]
  v_pk_fma_f32 v[138:139], v[138:139], v[250:251], v[250:251] op_sel:[0,0,1] op_sel_hi:[1,0,1]
  v_pk_fma_f32 v[140:141], v[140:141], v[250:251], v[250:251] op_sel:[0,0,1] op_sel_hi:[1,0,1]
  v_pk_fma_f32 v[142:143], v[142:143], v[250:251], v[250:251] op_sel:[0,0,1] op_sel_hi:[1,0,1]
  s_cmp_lg_u32 s52, 0
  s_cbranch_scc1 L_pd_34
  s_waitcnt vmcnt(0)
L_pd_34:
  s_waitcnt lgkmcnt(0)
  ds_read_b64_tr_b16 v[200:201], v13 offset:0
  ds_read_b64_tr_b16 v[202:203], v13 offset:256
  ds_read_b64_tr_b16 v[204:205], v13 offset:16384
  ds_read_b64_tr_b16 v[206:207], v13 offset:16640
  ds_read_b64_tr_b16 v[208:209], v13 offset:32768
  ds_read_b64_tr_b16 v[210:211], v13 offset:33024
  ds_read_b128 v[232:235], v12 offset:2112
  ds_read_b128 v[236:239], v12 offset:2128
  v_fmac_f32_dpp v224, v192, v16 row_newbcast:0 row_mask:0xf bank_mask:0xf
  v_fmac_f32_dpp v225, v192, v17 row_newbcast:1 row_mask:0xf bank_mask:0xf
  v_fmac_f32_dpp v226, v192, v18 row_newbcast:2 row_mask:0xf bank_mask:0xf
  v_fmac_f32_dpp v227, v192, v19 row_newbcast:3 row_mask:0xf bank_mask:0xf
  v_cvt_pk_bf16_f32 v240, v224, v225
  v_fmac_f32_dpp v228, v192, v20 row_newbcast:4 row_mask:0xf bank_mask:0xf
  v_fmac_f32_dpp v229, v192, v21 row_newbcast:5 row_mask:0xf bank_mask:0xf
  v_cvt_pk_bf16_f32 v241, v226, v227
  v_fmac_f32_dpp v230, v192, v22 row_newbcast:6 row_mask:0xf bank_mask:0xf
  v_fmac_f32_dpp v231, v192, v23 row_newbcast:7 row_mask:0xf bank_mask:0xf
  v_cvt_pk_bf16_f32 v242, v228, v229
  v_cvt_pk_bf16_f32 v243, v230, v231
  s_waitcnt lgkmcnt(0)
  ds_read_b64_tr_b16 v[212:213], v13 offset:1024
  ds_read_b64_tr_b16 v[214:215], v13 offset:1280
  ds_read_b64_tr_b16 v[216:217], v13 offset:17408
  ds_read_b64_tr_b16 v[218:219], v13 offset:17664
  ds_read_b64_tr_b16 v[220:221], v13 offset:33792
  ds_read_b64_tr_b16 v[222:223], v13 offset:34048
  ds_read_b128 v[224:227], v12 offset:2176
  ds_read_b128 v[228:231], v12 offset:2192
  v_mfma_f32_32x32x16_bf16 v[144:159], v[200:203], v[240:243], 0
  v_fmac_f32_dpp v232, v192, v24 row_newbcast:8 row_mask:0xf bank_mask:0xf
  v_fmac_f32_dpp v233, v192, v25 row_newbcast:9 row_mask:0xf bank_mask:0xf
  v_fmac_f32_dpp v234, v192, v26 row_newbcast:10 row_mask:0xf bank_mask:0xf
  v_fmac_f32_dpp v235, v192, v27 row_newbcast:11 row_mask:0xf bank_mask:0xf
  v_cvt_pk_bf16_f32 v244, v232, v233
  v_mfma_f32_32x32x16_bf16 v[160:175], v[204:207], v[240:243], 0
  v_fmac_f32_dpp v236, v192, v28 row_newbcast:12 row_mask:0xf bank_mask:0xf
  v_fmac_f32_dpp v237, v192, v29 row_newbcast:13 row_mask:0xf bank_mask:0xf
  v_cvt_pk_bf16_f32 v245, v234, v235
  v_fmac_f32_dpp v238, v192, v30 row_newbcast:14 row_mask:0xf bank_mask:0xf
  v_fmac_f32_dpp v239, v192, v31 row_newbcast:15 row_mask:0xf bank_mask:0xf
  v_mfma_f32_32x32x16_bf16 v[176:191], v[240:243], v[208:211], 0
  v_cvt_pk_bf16_f32 v246, v236, v237
  v_cvt_pk_bf16_f32 v247, v238, v239
  s_waitcnt lgkmcnt(0)
  ds_read_b64_tr_b16 v[200:201], v13 offset:2048
  ds_read_b64_tr_b16 v[202:203], v13 offset:2304
  ds_read_b64_tr_b16 v[204:205], v13 offset:18432
  ds_read_b64_tr_b16 v[206:207], v13 offset:18688
  ds_read_b64_tr_b16 v[208:209], v13 offset:34816
  ds_read_b64_tr_b16 v[210:211], v13 offset:35072
  ds_read_b128 v[232:235], v12 offset:2240
  ds_read_b128 v[236:239], v12 offset:2256
  v_mfma_f32_32x32x16_bf16 v[144:159], v[212:215], v[244:247], v[144:159]
  v_fmac_f32_dpp v224, v193, v32 row_newbcast:0 row_mask:0xf bank_mask:0xf
  v_fmac_f32_dpp v225, v193, v33 row_newbcast:1 row_mask:0xf bank_mask:0xf
  v_fmac_f32_dpp v226, v193, v34 row_newbcast:2 row_mask:0xf bank_mask:0xf
  v_fmac_f32_dpp v227, v193, v35 row_newbcast:3 row_mask:0xf bank_mask:0xf
  v_cvt_pk_bf16_f32 v240, v224, v225
  v_mfma_f32_32x32x16_bf16 v[160:175], v[216:219], v[244:247], v[160:175]
  v_fmac_f32_dpp v228, v193, v36 row_newbcast:4 row_mask:0xf bank_mask:0xf
  v_fmac_f32_dpp v229, v193, v37 row_newbcast:5 row_mask:0xf bank_mask:0xf
  v_cvt_pk_bf16_f32 v241, v226, v227
  v_fmac_f32_dpp v230, v193, v38 row_newbcast:6 row_mask:0xf bank_mask:0xf
  v_fmac_f32_dpp v231, v193, v39 row_newbcast:7 row_mask:0xf bank_mask:0xf
  v_mfma_f32_32x32x16_bf16 v[176:191], v[244:247], v[220:223], v[176:191]
  v_cvt_pk_bf16_f32 v242, v228, v229
  v_cvt_pk_bf16_f32 v243, v230, v231
  s_waitcnt lgkmcnt(0)
  ds_read_b64_tr_b16 v[212:213], v13 offset:3072
  ds_read_b64_tr_b16 v[214:215], v13 offset:3328
  ds_read_b64_tr_b16 v[216:217], v13 offset:19456
  ds_read_b64_tr_b16 v[218:219], v13 offset:19712
  ds_read_b64_tr_b16 v[220:221], v13 offset:35840
  ds_read_b64_tr_b16 v[222:223], v13 offset:36096
  ds_read_b128 v[224:227], v12 offset:2304
  ds_read_b128 v[228:231], v12 offset:2320
  v_mfma_f32_32x32x16_bf16 v[144:159], v[200:203], v[240:243], v[144:159]
  v_fmac_f32_dpp v232, v193, v40 row_newbcast:8 row_mask:0xf bank_mask:0xf
  v_fmac_f32_dpp v233, v193, v41 row_newbcast:9 row_mask:0xf bank_mask:0xf
  v_fmac_f32_dpp v234, v193, v42 row_newbcast:10 row_mask:0xf bank_mask:0xf
  v_fmac_f32_dpp v235, v193, v43 row_newbcast:11 row_mask:0xf bank_mask:0xf
  v_cvt_pk_bf16_f32 v244, v232, v233
  v_mfma_f32_32x32x16_bf16 v[160:175], v[204:207], v[240:243], v[160:175]
  v_fmac_f32_dpp v236, v193, v44 row_newbcast:12 row_mask:0xf bank_mask:0xf
  v_fmac_f32_dpp v237, v193, v45 row_newbcast:13 row_mask:0xf bank_mask:0xf
  v_cvt_pk_bf16_f32 v245, v234, v235
  v_fmac_f32_dpp v238, v193, v46 row_newbcast:14 row_mask:0xf bank_mask:0xf
  v_fmac_f32_dpp v239, v193, v47 row_newbcast:15 row_mask:0xf bank_mask:0xf
  v_mfma_f32_32x32x16_bf16 v[176:191], v[240:243], v[208:211], v[176:191]
  v_cvt_pk_bf16_f32 v246, v236, v237
  v_cvt_pk_bf16_f32 v247, v238, v239
  s_waitcnt vmcnt(0) lgkmcnt(0)
  s_barrier
  ds_read_b64_tr_b16 v[200:201], v13 offset:4096
  ds_read_b64_tr_b16 v[202:203], v13 offset:4352
  ds_read_b64_tr_b16 v[204:205], v13 offset:20480
  ds_read_b64_tr_b16 v[206:207], v13 offset:20736
  ds_read_b64_tr_b16 v[208:209], v13 offset:36864
  ds_read_b64_tr_b16 v[210:211], v13 offset:37120
  ds_read_b128 v[232:235], v12 offset:2368
  ds_read_b128 v[236:239], v12 offset:2384
  v_mfma_f32_32x32x16_bf16 v[144:159], v[212:215], v[244:247], v[144:159]
  v_fmac_f32_dpp v224, v194, v48 row_newbcast:0 row_mask:0xf bank_mask:0xf
  v_fmac_f32_dpp v225, v194, v49 row_newbcast:1 row_mask:0xf bank_mask:0xf
  v_fmac_f32_dpp v226, v194, v50 row_newbcast:2 row_mask:0xf bank_mask:0xf
  v_fmac_f32_dpp v227, v194, v51 row_newbcast:3 row_mask:0xf bank_mask:0xf
  v_cvt_pk_bf16_f32 v240, v224, v225
  v_mfma_f32_32x32x16_bf16 v[160:175], v[216:219], v[244:247], v[160:175]
  v_fmac_f32_dpp v228, v194, v52 row_newbcast:4 row_mask:0xf bank_mask:0xf
  v_fmac_f32_dpp v229, v194, v53 row_newbcast:5 row_mask:0xf bank_mask:0xf
  s_cmp_eq_u32 s94, 0
  s_cbranch_scc1 L_w1_35
  s_add_u32 s93, s96, 3
  s_and_b32 s93, s93, 3
  s_mul_i32 s93, s93, 196608
  s_add_u32 s93, s93, s97
  s_mov_b32 m0, s92
  s_add_u32 s92, s92, 1024
  buffer_load_dwordx4 v2, s[12:15], s93 offen lds
  s_add_u32 s93, s93, 49152
L_w1_35:
  v_cvt_pk_bf16_f32 v241, v226, v227
  v_fmac_f32_dpp v230, v194, v54 row_newbcast:6 row_mask:0xf bank_mask:0xf
  v_fmac_f32_dpp v231, v194, v55 row_newbcast:7 row_mask:0xf bank_mask:0xf
  v_mfma_f32_32x32x16_bf16 v[176:191], v[244:247], v[220:223], v[176:191]
  v_cvt_pk_bf16_f32 v242, v228, v229
  v_cvt_pk_bf16_f32 v243, v230, v231
  s_waitcnt lgkmcnt(0)
  ds_read_b64_tr_b16 v[212:213], v13 offset:5120
  ds_read_b64_tr_b16 v[214:215], v13 offset:5376
  ds_read_b64_tr_b16 v[216:217], v13 offset:21504
  ds_read_b64_tr_b16 v[218:219], v13 offset:21760
  ds_read_b64_tr_b16 v[220:221], v13 offset:37888
  ds_read_b64_tr_b16 v[222:223], v13 offset:38144
  ds_read_b128 v[224:227], v12 offset:2432
  ds_read_b128 v[228:231], v12 offset:2448
  v_mfma_f32_32x32x16_bf16 v[144:159], v[200:203], v[240:243], v[144:159]
  v_fmac_f32_dpp v232, v194, v56 row_newbcast:8 row_mask:0xf bank_mask:0xf
  v_fmac_f32_dpp v233, v194, v57 row_newbcast:9 row_mask:0xf bank_mask:0xf
  v_fmac_f32_dpp v234, v194, v58 row_newbcast:10 row_mask:0xf bank_mask:0xf
  v_fmac_f32_dpp v235, v194, v59 row_newbcast:11 row_mask:0xf bank_mask:0xf
  v_cvt_pk_bf16_f32 v244, v232, v233
  v_mfma_f32_32x32x16_bf16 v[160:175], v[204:207], v[240:243], v[160:175]
  v_fmac_f32_dpp v236, v194, v60 row_newbcast:12 row_mask:0xf bank_mask:0xf
  v_fmac_f32_dpp v237, v194, v61 row_newbcast:13 row_mask:0xf bank_mask:0xf
  s_cmp_eq_u32 s94, 0
  s_cbranch_scc1 L_w1_36
  s_mov_b32 m0, s92
  s_add_u32 s92, s92, 1024
  buffer_load_dwordx4 v2, s[12:15], s93 offen lds
  s_add_u32 s93, s93, 49152
L_w1_36:
  v_cvt_pk_bf16_f32 v245, v234, v235
  v_fmac_f32_dpp v238, v194, v62 row_newbcast:14 row_mask:0xf bank_mask:0xf
  v_fmac_f32_dpp v239, v194, v63 row_newbcast:15 row_mask:0xf bank_mask:0xf
  v_mfma_f32_32x32x16_bf16 v[176:191], v[240:243], v[208:211], v[176:191]
  v_cvt_pk_bf16_f32 v246, v236, v237
  v_cvt_pk_bf16_f32 v247, v238, v239
  s_waitcnt lgkmcnt(0)
  ds_read_b64_tr_b16 v[200:201], v13 offset:6144
  ds_read_b64_tr_b16 v[202:203], v13 offset:6400
  ds_read_b64_tr_b16 v[204:205], v13 offset:22528
  ds_read_b64_tr_b16 v[206:207], v13 offset:22784
  ds_read_b64_tr_b16 v[208:209], v13 offset:38912
  ds_read_b64_tr_b16 v[210:211], v13 offset:39168
  ds_read_b128 v[232:235], v12 offset:2496
  ds_read_b128 v[236:239], v12 offset:2512
  v_mfma_f32_32x32x16_bf16 v[144:159], v[212:215], v[244:247], v[144:159]
  v_fmac_f32_dpp v224, v195, v64 row_newbcast:0 row_mask:0xf bank_mask:0xf
  v_fmac_f32_dpp v225, v195, v65 row_newbcast:1 row_mask:0xf bank_mask:0xf
  v_fmac_f32_dpp v226, v195, v66 row_newbcast:2 row_mask:0xf bank_mask:0xf
  v_fmac_f32_dpp v227, v195, v67 row_newbcast:3 row_mask:0xf bank_mask:0xf
  v_cvt_pk_bf16_f32 v240, v224, v225
  v_mfma_f32_32x32x16_bf16 v[160:175], v[216:219], v[244:247], v[160:175]
  v_fmac_f32_dpp v228, v195, v68 row_newbcast:4 row_mask:0xf bank_mask:0xf
  v_fmac_f32_dpp v229, v195, v69 row_newbcast:5 row_mask:0xf bank_mask:0xf
  s_cmp_eq_u32 s94, 0
  s_cbranch_scc1 L_w1_37
  s_mov_b32 m0, s92
  s_add_u32 s92, s92, 1024
  buffer_load_dwordx4 v2, s[12:15], s93 offen lds
  s_add_u32 s93, s93, 49152
L_w1_37:
  v_cvt_pk_bf16_f32 v241, v226, v227
  v_fmac_f32_dpp v230, v195, v70 row_newbcast:6 row_mask:0xf bank_mask:0xf
  v_fmac_f32_dpp v231, v195, v71 row_newbcast:7 row_mask:0xf bank_mask:0xf
  v_mfma_f32_32x32x16_bf16 v[176:191], v[244:247], v[220:223], v[176:191]
  v_cvt_pk_bf16_f32 v242, v228, v229
  v_cvt_pk_bf16_f32 v243, v230, v231
  s_waitcnt lgkmcnt(0)
  ds_read_b64_tr_b16 v[212:213], v13 offset:7168
  ds_read_b64_tr_b16 v[214:215], v13 offset:7424
  ds_read_b64_tr_b16 v[216:217], v13 offset:23552
  ds_read_b64_tr_b16 v[218:219], v13 offset:23808
  ds_read_b64_tr_b16 v[220:221], v13 offset:39936
  ds_read_b64_tr_b16 v[222:223], v13 offset:40192
  ds_read_b128 v[224:227], v12 offset:2560
  ds_read_b128 v[228:231], v12 offset:2576
  v_mfma_f32_32x32x16_bf16 v[144:159], v[200:203], v[240:243], v[144:159]
  v_fmac_f32_dpp v232, v195, v72 row_newbcast:8 row_mask:0xf bank_mask:0xf
  v_fmac_f32_dpp v233, v195, v73 row_newbcast:9 row_mask:0xf bank_mask:0xf
  v_fmac_f32_dpp v234, v195, v74 row_newbcast:10 row_mask:0xf bank_mask:0xf
  v_fmac_f32_dpp v235, v195, v75 row_newbcast:11 row_mask:0xf bank_mask:0xf
  v_cvt_pk_bf16_f32 v244, v232, v233
  v_mfma_f32_32x32x16_bf16 v[160:175], v[204:207], v[240:243], v[160:175]
  v_fmac_f32_dpp v236, v195, v76 row_newbcast:12 row_mask:0xf bank_mask:0xf
  v_fmac_f32_dpp v237, v195, v77 row_newbcast:13 row_mask:0xf bank_mask:0xf
  s_cmp_eq_u32 s94, 0
  s_cbranch_scc1 L_w1_38
  s_mov_b32 m0, s92
  s_add_u32 s92, s92, 1024
  buffer_load_dwordx4 v2, s[12:15], s93 offen lds
  s_add_u32 s93, s93, 49152
L_w1_38:
  v_cvt_pk_bf16_f32 v245, v234, v235
  v_fmac_f32_dpp v238, v195, v78 row_newbcast:14 row_mask:0xf bank_mask:0xf
  v_fmac_f32_dpp v239, v195, v79 row_newbcast:15 row_mask:0xf bank_mask:0xf
  v_mfma_f32_32x32x16_bf16 v[176:191], v[240:243], v[208:211], v[176:191]
  v_cvt_pk_bf16_f32 v246, v236, v237
  v_cvt_pk_bf16_f32 v247, v238, v239
  s_waitcnt lgkmcnt(0)
  ds_read_b64_tr_b16 v[200:201], v13 offset:8192
  ds_read_b64_tr_b16 v[202:203], v13 offset:8448
  ds_read_b64_tr_b16 v[204:205], v13 offset:24576
  ds_read_b64_tr_b16 v[206:207], v13 offset:24832
  ds_read_b64_tr_b16 v[208:209], v13 offset:40960
  ds_read_b64_tr_b16 v[210:211], v13 offset:41216
  ds_read_b128 v[232:235], v12 offset:2624
  ds_read_b128 v[236:239], v12 offset:2640
  v_mfma_f32_32x32x16_bf16 v[144:159], v[212:215], v[244:247], v[144:159]
  v_fmac_f32_dpp v224, v196, v80 row_newbcast:0 row_mask:0xf bank_mask:0xf
  v_fmac_f32_dpp v225, v196, v81 row_newbcast:1 row_mask:0xf bank_mask:0xf
  v_fmac_f32_dpp v226, v196, v82 row_newbcast:2 row_mask:0xf bank_mask:0xf
  v_fmac_f32_dpp v227, v196, v83 row_newbcast:3 row_mask:0xf bank_mask:0xf
  v_cvt_pk_bf16_f32 v240, v224, v225
  v_mfma_f32_32x32x16_bf16 v[160:175], v[216:219], v[244:247], v[160:175]
  v_fmac_f32_dpp v228, v196, v84 row_newbcast:4 row_mask:0xf bank_mask:0xf
  v_fmac_f32_dpp v229, v196, v85 row_newbcast:5 row_mask:0xf bank_mask:0xf
  v_cvt_pk_bf16_f32 v241, v226, v227
  v_fmac_f32_dpp v230, v196, v86 row_newbcast:6 row_mask:0xf bank_mask:0xf
  v_fmac_f32_dpp v231, v196, v87 row_newbcast:7 row_mask:0xf bank_mask:0xf
  v_mfma_f32_32x32x16_bf16 v[176:191], v[244:247], v[220:223], v[176:191]
  v_cvt_pk_bf16_f32 v242, v228, v229
  v_cvt_pk_bf16_f32 v243, v230, v231
  s_waitcnt lgkmcnt(0)
  ds_read_b64_tr_b16 v[212:213], v13 offset:9216
  ds_read_b64_tr_b16 v[214:215], v13 offset:9472
  ds_read_b64_tr_b16 v[216:217], v13 offset:25600
  ds_read_b64_tr_b16 v[218:219], v13 offset:25856
  ds_read_b64_tr_b16 v[220:221], v13 offset:41984
  ds_read_b64_tr_b16 v[222:223], v13 offset:42240
  ds_read_b128 v[224:227], v12 offset:2688
  ds_read_b128 v[228:231], v12 offset:2704
  v_mfma_f32_32x32x16_bf16 v[144:159], v[200:203], v[240:243], v[144:159]
  v_fmac_f32_dpp v232, v196, v88 row_newbcast:8 row_mask:0xf bank_mask:0xf
  v_fmac_f32_dpp v233, v196, v89 row_newbcast:9 row_mask:0xf bank_mask:0xf
  v_fmac_f32_dpp v234, v196, v90 row_newbcast:10 row_mask:0xf bank_mask:0xf
  v_fmac_f32_dpp v235, v196, v91 row_newbcast:11 row_mask:0xf bank_mask:0xf
  v_cvt_pk_bf16_f32 v244, v232, v233
  v_mfma_f32_32x32x16_bf16 v[160:175], v[204:207], v[240:243], v[160:175]
  v_fmac_f32_dpp v236, v196, v92 row_newbcast:12 row_mask:0xf bank_mask:0xf
  v_fmac_f32_dpp v237, v196, v93 row_newbcast:13 row_mask:0xf bank_mask:0xf
  s_lshr_b32 s66, s55, 3
  s_lshl_b32 s66, s66, 3
  s_add_u32 s66, s66, s54
  s_lshl_b32 s66, s66, 3
  s_and_b32 s67, s55, 7
  s_add_u32 s62, s66, s67
  v_mul_u32_u24 v3, 6144, v0
  s_lshl_b32 s66, s62, 4
  s_add_u32 s66, s66, 2048
  v_add_u32 v3, s66, v3
  s_lshl_b32 s67, s52, 10
  s_add_u32 m0, s67, 155648
  s_nop 0
  buffer_load_dwordx4 v3, s[28:31], 0 offen lds
  v_cvt_pk_bf16_f32 v245, v234, v235
  v_fmac_f32_dpp v238, v196, v94 row_newbcast:14 row_mask:0xf bank_mask:0xf
  v_fmac_f32_dpp v239, v196, v95 row_newbcast:15 row_mask:0xf bank_mask:0xf
  v_mfma_f32_32x32x16_bf16 v[176:191], v[240:243], v[208:211], v[176:191]
  v_cvt_pk_bf16_f32 v246, v236, v237
  v_cvt_pk_bf16_f32 v247, v238, v239
  s_waitcnt lgkmcnt(0)
  ds_read_b64_tr_b16 v[200:201], v13 offset:10240
  ds_read_b64_tr_b16 v[202:203], v13 offset:10496
  ds_read_b64_tr_b16 v[204:205], v13 offset:26624
  ds_read_b64_tr_b16 v[206:207], v13 offset:26880
  ds_read_b64_tr_b16 v[208:209], v13 offset:43008
  ds_read_b64_tr_b16 v[210:211], v13 offset:43264
  ds_read_b128 v[232:235], v12 offset:2752
  ds_read_b128 v[236:239], v12 offset:2768
  v_mfma_f32_32x32x16_bf16 v[144:159], v[212:215], v[244:247], v[144:159]
  v_fmac_f32_dpp v224, v197, v96 row_newbcast:0 row_mask:0xf bank_mask:0xf
  v_fmac_f32_dpp v225, v197, v97 row_newbcast:1 row_mask:0xf bank_mask:0xf
  v_fmac_f32_dpp v226, v197, v98 row_newbcast:2 row_mask:0xf bank_mask:0xf
  v_fmac_f32_dpp v227, v197, v99 row_newbcast:3 row_mask:0xf bank_mask:0xf
  v_cvt_pk_bf16_f32 v240, v224, v225
  v_mfma_f32_32x32x16_bf16 v[160:175], v[216:219], v[244:247], v[160:175]
  v_fmac_f32_dpp v228, v197, v100 row_newbcast:4 row_mask:0xf bank_mask:0xf
  v_fmac_f32_dpp v229, v197, v101 row_newbcast:5 row_mask:0xf bank_mask:0xf
  s_cmp_lg_u32 s52, 0
  s_cbranch_scc1 L_tc_40
  v_and_b32 v251, 15, v1
  v_lshrrev_b32 v252, 2, v251
  v_and_b32 v251, 3, v251
  s_lshr_b32 s66, s58, 1
  s_and_b32 s67, s66, 7
  s_lshl_b32 s67, s67, 2
  v_add_u32 v251, s67, v251
  v_lshlrev_b32 v251, 3, v251
  s_lshr_b32 s66, s66, 3
  s_lshl_b32 s66, s66, 2
  v_add_u32 v251, s66, v251
  v_add_u32 v251, v251, v252
  v_lshlrev_b32 v251, 7, v251
  v_add_u32 v251, 32768, v251
  s_lshl_b32 s66, s2, 7
  s_add_u32 s66, s66, 32768
  v_mov_b32 v252, s66
  v_cmp_gt_u32 vcc, 16, v1
  s_nop 1
  v_cndmask_b32 v251, v252, v251, vcc
  buffer_load_dword v251, v251, s[20:23], 0 offen sc1
  s_branch L_tce_39
L_tc_40:
  s_cmp_lg_u32 s52, 2
  s_cbranch_scc1 L_tc_41
  s_lshr_b32 s66, s2, 6
  s_cmp_lg_u32 s66, 1
  s_cbranch_scc1 L_tc_41
  s_and_b32 s66, s2, 63
  s_lshl_b32 s66, s66, 7
  s_and_b32 s67, s55, 1
  s_lshl_b32 s67, s67, 13
  s_add_u32 s66, s66, s67
  s_add_u32 s66, s66, 917504
  v_mov_b32 v251, s66
  v_mov_b32 v252, s53
  s_mov_b64 exec, 1
  buffer_store_dword v252, v251, s[20:23], 0 offen sc1
  s_mov_b64 exec, -1
  s_branch L_tce_39
L_tc_41:
  s_bitcmp1_b32 s52, 0
  s_cbranch_scc0 L_tc_42
  s_lshl_b32 s66, s55, 3
  s_add_u32 s66, s66, s52
  s_sub_u32 s66, s66, 1
  s_lshl_b32 s66, s66, 11
  v_and_b32 v251, 31, v1
  v_lshl_add_u32 v251, v251, 7, s66
  buffer_load_dword v251, v251, s[16:19], 0 offen
  s_branch L_tce_39
L_tc_42:
  buffer_load_dword v251, off, s[32:35], 0
L_tce_39:
  v_cvt_pk_bf16_f32 v241, v226, v227
  v_fmac_f32_dpp v230, v197, v102 row_newbcast:6 row_mask:0xf bank_mask:0xf
  v_fmac_f32_dpp v231, v197, v103 row_newbcast:7 row_mask:0xf bank_mask:0xf
  v_mfma_f32_32x32x16_bf16 v[176:191], v[244:247], v[220:223], v[176:191]
  v_cvt_pk_bf16_f32 v242, v228, v229
  v_cvt_pk_bf16_f32 v243, v230, v231
  s_waitcnt lgkmcnt(0)
  ds_read_b64_tr_b16 v[212:213], v13 offset:11264
  ds_read_b64_tr_b16 v[214:215], v13 offset:11520
  ds_read_b64_tr_b16 v[216:217], v13 offset:27648
  ds_read_b64_tr_b16 v[218:219], v13 offset:27904
  ds_read_b64_tr_b16 v[220:221], v13 offset:44032
  ds_read_b64_tr_b16 v[222:223], v13 offset:44288
  ds_read_b128 v[224:227], v12 offset:2816
  ds_read_b128 v[228:231], v12 offset:2832
  v_mfma_f32_32x32x16_bf16 v[144:159], v[200:203], v[240:243], v[144:159]
  v_fmac_f32_dpp v232, v197, v104 row_newbcast:8 row_mask:0xf bank_mask:0xf
  v_fmac_f32_dpp v233, v197, v105 row_newbcast:9 row_mask:0xf bank_mask:0xf
  v_fmac_f32_dpp v234, v197, v106 row_newbcast:10 row_mask:0xf bank_mask:0xf
  v_fmac_f32_dpp v235, v197, v107 row_newbcast:11 row_mask:0xf bank_mask:0xf
  v_cvt_pk_bf16_f32 v244, v232, v233
  v_mfma_f32_32x32x16_bf16 v[160:175], v[204:207], v[240:243], v[160:175]
  v_fmac_f32_dpp v236, v197, v108 row_newbcast:12 row_mask:0xf bank_mask:0xf
  v_fmac_f32_dpp v237, v197, v109 row_newbcast:13 row_mask:0xf bank_mask:0xf
  v_cvt_pk_bf16_f32 v245, v234, v235
  v_fmac_f32_dpp v238, v197, v110 row_newbcast:14 row_mask:0xf bank_mask:0xf
  v_fmac_f32_dpp v239, v197, v111 row_newbcast:15 row_mask:0xf bank_mask:0xf
  v_mfma_f32_32x32x16_bf16 v[176:191], v[240:243], v[208:211], v[176:191]
  v_cvt_pk_bf16_f32 v246, v236, v237
  v_cvt_pk_bf16_f32 v247, v238, v239
  s_waitcnt vmcnt(2) lgkmcnt(0)
  s_barrier
  ds_read_b64_tr_b16 v[200:201], v13 offset:12288
  ds_read_b64_tr_b16 v[202:203], v13 offset:12544
  ds_read_b64_tr_b16 v[204:205], v13 offset:28672
  ds_read_b64_tr_b16 v[206:207], v13 offset:28928
  ds_read_b64_tr_b16 v[208:209], v13 offset:45056
  ds_read_b64_tr_b16 v[210:211], v13 offset:45312
  ds_read_b128 v[232:235], v12 offset:2880
  ds_read_b128 v[236:239], v12 offset:2896
  v_mfma_f32_32x32x16_bf16 v[144:159], v[212:215], v[244:247], v[144:159]
  v_fmac_f32_dpp v224, v198, v112 row_newbcast:0 row_mask:0xf bank_mask:0xf
  v_fmac_f32_dpp v225, v198, v113 row_newbcast:1 row_mask:0xf bank_mask:0xf
  v_fmac_f32_dpp v226, v198, v114 row_newbcast:2 row_mask:0xf bank_mask:0xf
  v_fmac_f32_dpp v227, v198, v115 row_newbcast:3 row_mask:0xf bank_mask:0xf
  v_cvt_pk_bf16_f32 v240, v224, v225
  v_mfma_f32_32x32x16_bf16 v[160:175], v[216:219], v[244:247], v[160:175]
  v_fmac_f32_dpp v228, v198, v116 row_newbcast:4 row_mask:0xf bank_mask:0xf
  v_fmac_f32_dpp v229, v198, v117 row_newbcast:5 row_mask:0xf bank_mask:0xf
  v_cvt_pk_bf16_f32 v241, v226, v227
  v_fmac_f32_dpp v230, v198, v118 row_newbcast:6 row_mask:0xf bank_mask:0xf
  v_fmac_f32_dpp v231, v198, v119 row_newbcast:7 row_mask:0xf bank_mask:0xf
  v_mfma_f32_32x32x16_bf16 v[176:191], v[244:247], v[220:223], v[176:191]
  v_cvt_pk_bf16_f32 v242, v228, v229
  v_cvt_pk_bf16_f32 v243, v230, v231
  s_waitcnt lgkmcnt(0)
  ds_read_b64_tr_b16 v[212:213], v13 offset:13312
  ds_read_b64_tr_b16 v[214:215], v13 offset:13568
  ds_read_b64_tr_b16 v[216:217], v13 offset:29696
  ds_read_b64_tr_b16 v[218:219], v13 offset:29952
  ds_read_b64_tr_b16 v[220:221], v13 offset:46080
  ds_read_b64_tr_b16 v[222:223], v13 offset:46336
  ds_read_b128 v[224:227], v12 offset:2944
  ds_read_b128 v[228:231], v12 offset:2960
  v_mfma_f32_32x32x16_bf16 v[144:159], v[200:203], v[240:243], v[144:159]
  v_fmac_f32_dpp v232, v198, v120 row_newbcast:8 row_mask:0xf bank_mask:0xf
  v_fmac_f32_dpp v233, v198, v121 row_newbcast:9 row_mask:0xf bank_mask:0xf
  v_fmac_f32_dpp v234, v198, v122 row_newbcast:10 row_mask:0xf bank_mask:0xf
  v_fmac_f32_dpp v235, v198, v123 row_newbcast:11 row_mask:0xf bank_mask:0xf
  v_cvt_pk_bf16_f32 v244, v232, v233
  v_mfma_f32_32x32x16_bf16 v[160:175], v[204:207], v[240:243], v[160:175]
  v_fmac_f32_dpp v236, v198, v124 row_newbcast:12 row_mask:0xf bank_mask:0xf
  v_fmac_f32_dpp v237, v198, v125 row_newbcast:13 row_mask:0xf bank_mask:0xf
  v_cvt_pk_bf16_f32 v245, v234, v235
  v_fmac_f32_dpp v238, v198, v126 row_newbcast:14 row_mask:0xf bank_mask:0xf
  v_fmac_f32_dpp v239, v198, v127 row_newbcast:15 row_mask:0xf bank_mask:0xf
  v_mfma_f32_32x32x16_bf16 v[176:191], v[240:243], v[208:211], v[176:191]
  v_cvt_pk_bf16_f32 v246, v236, v237
  v_cvt_pk_bf16_f32 v247, v238, v239
  s_waitcnt lgkmcnt(0)
  ds_read_b64_tr_b16 v[200:201], v13 offset:14336
  ds_read_b64_tr_b16 v[202:203], v13 offset:14592
  ds_read_b64_tr_b16 v[204:205], v13 offset:30720
  ds_read_b64_tr_b16 v[206:207], v13 offset:30976
  ds_read_b64_tr_b16 v[208:209], v13 offset:47104
  ds_read_b64_tr_b16 v[210:211], v13 offset:47360
  ds_read_b128 v[232:235], v12 offset:3008
  ds_read_b128 v[236:239], v12 offset:3024
  v_mfma_f32_32x32x16_bf16 v[144:159], v[212:215], v[244:247], v[144:159]
  v_fmac_f32_dpp v224, v199, v128 row_newbcast:0 row_mask:0xf bank_mask:0xf
  v_fmac_f32_dpp v225, v199, v129 row_newbcast:1 row_mask:0xf bank_mask:0xf
  v_fmac_f32_dpp v226, v199, v130 row_newbcast:2 row_mask:0xf bank_mask:0xf
  v_fmac_f32_dpp v227, v199, v131 row_newbcast:3 row_mask:0xf bank_mask:0xf
  v_cvt_pk_bf16_f32 v240, v224, v225
  v_mfma_f32_32x32x16_bf16 v[160:175], v[216:219], v[244:247], v[160:175]
  v_fmac_f32_dpp v228, v199, v132 row_newbcast:4 row_mask:0xf bank_mask:0xf
  v_fmac_f32_dpp v229, v199, v133 row_newbcast:5 row_mask:0xf bank_mask:0xf
  v_cvt_pk_bf16_f32 v241, v226, v227
  v_fmac_f32_dpp v230, v199, v134 row_newbcast:6 row_mask:0xf bank_mask:0xf
  v_fmac_f32_dpp v231, v199, v135 row_newbcast:7 row_mask:0xf bank_mask:0xf
  v_mfma_f32_32x32x16_bf16 v[176:191], v[244:247], v[220:223], v[176:191]
  v_cvt_pk_bf16_f32 v242, v228, v229
  v_cvt_pk_bf16_f32 v243, v230, v231
  s_waitcnt lgkmcnt(0)
  ds_read_b64_tr_b16 v[212:213], v13 offset:15360
  ds_read_b64_tr_b16 v[214:215], v13 offset:15616
  ds_read_b64_tr_b16 v[216:217], v13 offset:31744
  ds_read_b64_tr_b16 v[218:219], v13 offset:32000
  ds_read_b64_tr_b16 v[220:221], v13 offset:48128
  ds_read_b64_tr_b16 v[222:223], v13 offset:48384
  v_mfma_f32_32x32x16_bf16 v[144:159], v[200:203], v[240:243], v[144:159]
  v_fmac_f32_dpp v232, v199, v136 row_newbcast:8 row_mask:0xf bank_mask:0xf
  v_fmac_f32_dpp v233, v199, v137 row_newbcast:9 row_mask:0xf bank_mask:0xf
  v_fmac_f32_dpp v234, v199, v138 row_newbcast:10 row_mask:0xf bank_mask:0xf
  v_fmac_f32_dpp v235, v199, v139 row_newbcast:11 row_mask:0xf bank_mask:0xf
  v_cvt_pk_bf16_f32 v244, v232, v233
  v_mfma_f32_32x32x16_bf16 v[160:175], v[204:207], v[240:243], v[160:175]
  v_fmac_f32_dpp v236, v199, v140 row_newbcast:12 row_mask:0xf bank_mask:0xf
  v_fmac_f32_dpp v237, v199, v141 row_newbcast:13 row_mask:0xf bank_mask:0xf
  v_cvt_pk_bf16_f32 v245, v234, v235
  v_fmac_f32_dpp v238, v199, v142 row_newbcast:14 row_mask:0xf bank_mask:0xf
  v_fmac_f32_dpp v239, v199, v143 row_newbcast:15 row_mask:0xf bank_mask:0xf
  v_mfma_f32_32x32x16_bf16 v[176:191], v[240:243], v[208:211], v[176:191]
  v_cvt_pk_bf16_f32 v246, v236, v237
  v_cvt_pk_bf16_f32 v247, v238, v239
  s_waitcnt lgkmcnt(0)
  s_nop 0
  v_mfma_f32_32x32x16_bf16 v[144:159], v[212:215], v[244:247], v[144:159]
  v_mfma_f32_32x32x16_bf16 v[160:175], v[216:219], v[244:247], v[160:175]
  v_mfma_f32_32x32x16_bf16 v[176:191], v[244:247], v[220:223], v[176:191]
  s_lshl_b32 s66, s64, 1
  s_add_u32 s66, s66, s63
  s_mul_i32 s67, s66, 6144
  s_add_u32 s67, s67, 98304
  v_lshl_add_u32 v10, v1, 4, s67
  s_xor_b32 s66, s66, 1
  s_mul_i32 s67, s66, 6144
  s_add_u32 s67, s67, 98304
  v_lshl_add_u32 v9, v1, 4, s67
  s_lshl_b32 s67, s56, 2
  s_add_u32 s67, s67, s64
  s_lshl_b32 s67, s67, 10
  s_lshl_b32 s68, s57, 17
  s_add_u32 s67, s67, s68
  v_lshlrev_b32 v11, 4, v1
  v_add_u32 v11, s67, v11
  v_bfe_u32 v8, v1, 4, 1
  v_lshlrev_b32 v8, 16, v8
  v_lshrrev_b32 v12, 5, v1
  v_lshl_add_u32 v8, v12, 8, v8
  v_and_b32 v12, 15, v1
  v_lshl_add_u32 v8, v12, 4, v8
  v_add_u32 v8, s67, v8
  s_mov_b32 s71, 5242880
  s_cmp_eq_u32 s63, 1
  s_cbranch_scc1 L_p2k1_43
  ds_write_b128 v10, v[160:163] offset:0
  ds_write_b128 v10, v[164:167] offset:1024
  ds_write_b128 v10, v[168:171] offset:2048
  ds_write_b128 v10, v[172:175] offset:3072
  ds_write_b128 v10, v[184:187] offset:4096
  ds_write_b128 v10, v[188:191] offset:5120
  s_branch L_p2j_44
L_p2k1_43:
  ds_write_b128 v10, v[144:147] offset:0
  ds_write_b128 v10, v[148:151] offset:1024
  ds_write_b128 v10, v[152:155] offset:2048
  ds_write_b128 v10, v[156:159] offset:3072
  ds_write_b128 v10, v[176:179] offset:4096
  ds_write_b128 v10, v[180:183] offset:5120
L_p2j_44:
  s_waitcnt lgkmcnt(0)
  s_barrier
  ds_read_b128 v[16:19], v9 offset:0
  ds_read_b128 v[20:23], v9 offset:1024
  ds_read_b128 v[24:27], v9 offset:2048
  ds_read_b128 v[28:31], v9 offset:3072
  ds_read_b128 v[32:35], v9 offset:4096
  ds_read_b128 v[36:39], v9 offset:5120
  s_cmp_eq_u32 s63, 1
  s_cbranch_scc1 L_p2k1_43b
  s_mov_b32 s69, 1048576
  s_mov_b32 s70, 1114112
  s_waitcnt lgkmcnt(2)
  v_add_f32 v144, v144, v16
  v_add_f32 v145, v145, v17
  v_add_f32 v146, v146, v18
  v_add_f32 v147, v147, v19
  v_add_f32 v148, v148, v20
  v_add_f32 v149, v149, v21
  v_add_f32 v150, v150, v22
  v_add_f32 v151, v151, v23
  v_add_f32 v152, v152, v24
  v_add_f32 v153, v153, v25
  v_add_f32 v154, v154, v26
  v_add_f32 v155, v155, v27
  v_add_f32 v156, v156, v28
  v_add_f32 v157, v157, v29
  v_add_f32 v158, v158, v30
  v_add_f32 v159, v159, v31
  v_mul_f32 v144, 0x3eb8aa3b, v144
  v_mul_f32 v145, 0x3eb8aa3b, v145
  v_mul_f32 v146, 0x3eb8aa3b, v146
  v_mul_f32 v147, 0x3eb8aa3b, v147
  v_mul_f32 v148, 0x3eb8aa3b, v148
  v_mul_f32 v149, 0x3eb8aa3b, v149
  v_mul_f32 v150, 0x3eb8aa3b, v150
  v_mul_f32 v151, 0x3eb8aa3b, v151
  v_mul_f32 v152, 0x3eb8aa3b, v152
  v_mul_f32 v153, 0x3eb8aa3b, v153
  v_mul_f32 v154, 0x3eb8aa3b, v154
  v_mul_f32 v155, 0x3eb8aa3b, v155
  v_mul_f32 v156, 0x3eb8aa3b, v156
  v_mul_f32 v157, 0x3eb8aa3b, v157
  v_mul_f32 v158, 0x3eb8aa3b, v158
  v_mul_f32 v159, 0x3eb8aa3b, v159
  v_cvt_pk_bf16_f32 v52, v144, v145
  v_cvt_pk_bf16_f32 v53, v146, v147
  v_cvt_pk_bf16_f32 v54, v148, v149
  v_cvt_pk_bf16_f32 v55, v150, v151
  v_cvt_pk_bf16_f32 v56, v152, v153
  v_cvt_pk_bf16_f32 v57, v154, v155
  v_cvt_pk_bf16_f32 v58, v156, v157
  v_cvt_pk_bf16_f32 v59, v158, v159
  buffer_store_dwordx4 v[52:55], v11, s[20:23], s69 offen sc1
  buffer_store_dwordx4 v[56:59], v11, s[20:23], s70 offen sc1
  s_waitcnt lgkmcnt(0)
  v_add_f32 v176, v176, v32
  v_add_f32 v177, v177, v33
  v_add_f32 v178, v178, v34
  v_add_f32 v179, v179, v35
  v_add_f32 v180, v180, v36
  v_add_f32 v181, v181, v37
  v_add_f32 v182, v182, v38
  v_add_f32 v183, v183, v39
  v_cvt_pk_bf16_f32 v60, v176, v177
  v_cvt_pk_bf16_f32 v61, v178, v179
  v_cvt_pk_bf16_f32 v62, v180, v181
  v_cvt_pk_bf16_f32 v63, v182, v183
  buffer_store_dwordx4 v[60:63], v8, s[20:23], s71 offen sc1
  s_branch L_p2j_45
L_p2k1_43b:
  s_mov_b32 s69, 3145728
  s_mov_b32 s70, 3211264
  s_waitcnt lgkmcnt(2)
  v_add_f32 v160, v160, v16
  v_add_f32 v161, v161, v17
  v_add_f32 v162, v162, v18
  v_add_f32 v163, v163, v19
  v_add_f32 v164, v164, v20
  v_add_f32 v165, v165, v21
  v_add_f32 v166, v166, v22
  v_add_f32 v167, v167, v23
  v_add_f32 v168, v168, v24
  v_add_f32 v169, v169, v25
  v_add_f32 v170, v170, v26
  v_add_f32 v171, v171, v27
  v_add_f32 v172, v172, v28
  v_add_f32 v173, v173, v29
  v_add_f32 v174, v174, v30
  v_add_f32 v175, v175, v31
  v_cvt_pk_bf16_f32 v52, v160, v161
  v_cvt_pk_bf16_f32 v53, v162, v163
  v_cvt_pk_bf16_f32 v54, v164, v165
  v_cvt_pk_bf16_f32 v55, v166, v167
  v_cvt_pk_bf16_f32 v56, v168, v169
  v_cvt_pk_bf16_f32 v57, v170, v171
  v_cvt_pk_bf16_f32 v58, v172, v173
  v_cvt_pk_bf16_f32 v59, v174, v175
  buffer_store_dwordx4 v[52:55], v11, s[20:23], s69 offen sc1
  buffer_store_dwordx4 v[56:59], v11, s[20:23], s70 offen sc1
  s_waitcnt lgkmcnt(0)
  v_add_f32 v184, v184, v32
  v_add_f32 v185, v185, v33
  v_add_f32 v186, v186, v34
  v_add_f32 v187, v187, v35
  v_add_f32 v188, v188, v36
  v_add_f32 v189, v189, v37
  v_add_f32 v190, v190, v38
  v_add_f32 v191, v191, v39
  v_cvt_pk_bf16_f32 v60, v184, v185
  v_cvt_pk_bf16_f32 v61, v186, v187
  v_cvt_pk_bf16_f32 v62, v188, v189
  v_cvt_pk_bf16_f32 v63, v190, v191
  buffer_store_dwordx4 v[60:63], v8, s[20:23], s71 offen offset:512 sc1
L_p2j_45:
  v_lshlrev_b32 v24, 16, v14
  v_mul_f32 v26, 0xbfb8aa3b, v24
  v_exp_f32 v26, v26
  s_lshl_b32 s66, s52, 7
  s_add_u32 s66, s66, 151552
  v_add_f32 v26, 1.0, v26
  v_rcp_f32 v26, v26
  v_lshl_add_u32 v3, v1, 1, s66
  v_lshrrev_b32 v7, 4, v1
  v_mul_f32 v24, v24, v26
  v_cvt_pk_bf16_f32 v24, v24, v24
  v_lshl_add_u32 v7, v7, 3, s66
  ds_write_b16 v3, v24
  v_lshrrev_b32 v6, 4, v1
  v_lshlrev_b32 v6, 2, v6
  v_bfe_u32 v8, v1, 2, 2
  v_add_u32 v6, v6, v8
  v_lshlrev_b32 v6, 4, v6
  v_and_b32 v8, 1, v1
  v_lshl_add_u32 v6, v8, 3, v6
  s_lshl_b32 s67, s52, 10
  s_add_u32 s67, s67, 155648
  v_add_u32 v6, s67, v6
  s_waitcnt vmcnt(4)
  s_waitcnt lgkmcnt(0)
  ds_read_b64_tr_b16 v[28:29], v6 offset:0
  ds_read_b64_tr_b16 v[30:31], v6 offset:256
  ds_read_b64 v[36:37], v7 offset:0
  ds_read_b64 v[38:39], v7 offset:32
  ds_read_b64_tr_b16 v[32:33], v6 offset:512
  ds_read_b64_tr_b16 v[34:35], v6 offset:768
  ds_read_b64 v[40:41], v7 offset:64
  ds_read_b64 v[42:43], v7 offset:96
  s_lshl_b32 s66, s52, 6
  s_add_u32 s66, s66, 154624
  v_and_b32 v5, 15, v1
  v_lshl_add_u32 v8, v5, 2, s66
  s_waitcnt lgkmcnt(0)
  v_mfma_f32_16x16x32_bf16 v[44:47], v[36:39], v[28:31], 0
  v_mfma_f32_16x16x32_bf16 v[44:47], v[40:43], v[32:35], v[44:47]
  s_nop 7
  s_mov_b64 exec, 0xffff
  ds_write_b32 v8, v44
  s_mov_b64 exec, -1
  s_lshl_b32 s95, s52, 12
  s_add_u32 s95, s95, 131072
  s_lshl_b32 s89, s52, 10
  s_add_u32 s65, s89, 3145728
  v_lshrrev_b32 v5, 2, v1
  v_lshlrev_b32 v5, 10, v5
  v_and_b32 v6, 3, v1
  v_lshl_add_u32 v5, v6, 4, v5
  s_lshl_b32 s66, s61, 8
  s_lshl_b32 s67, s64, 6
  s_add_u32 s66, s66, s67
  s_lshl_b32 s67, s63, 18
  s_add_u32 s66, s66, s67
  v_add_u32 v165, s66, v5
  v_lshrrev_b32 v6, 5, v1
  v_lshlrev_b32 v5, 8, v6
  v_bfe_u32 v6, v1, 2, 2
  v_lshl_add_u32 v5, v6, 6, v5
  v_and_b32 v6, 1, v1
  v_lshl_add_u32 v5, v6, 5, v5
  v_bfe_u32 v6, v1, 4, 1
  v_lshl_add_u32 v5, v6, 4, v5
  v_bfe_u32 v6, v1, 1, 1
  v_lshl_add_u32 v5, v6, 3, v5
  v_add_u32 v166, s95, v5
  s_and_b32 s66, s64, 1
  s_mul_i32 s75, s66, 7168
  s_lshr_b32 s66, s64, 1
  s_lshl_b32 s66, s66, 16
  s_add_u32 s75, s75, s66
  s_lshl_b32 s66, s63, 15
  s_add_u32 s75, s75, s66
  s_lshr_b32 s66, s55, 3
  s_lshl_b32 s66, s66, 3
  s_xor_b32 s68, s54, 0
  s_add_u32 s66, s66, s68
  s_cmp_ge_u32 s66, 28
  s_cselect_b32 s92, 1, 0
  s_lshl_b32 s66, s66, 3
  s_and_b32 s67, s55, 7
  s_add_u32 s93, s66, s67
  s_sub_u32 s66, s68, 4
  s_lshl_b32 s66, s66, 3
  s_add_u32 s66, s66, s67
  s_xor_b32 s66, s66, 0
  s_cmp_eq_u32 s92, 1
  s_cselect_b32 s93, s66, s93
  s_cmp_eq_u32 s92, 0
  s_cbranch_scc1 L_jgu_46
  v_lshrrev_b32 v5, 1, v1
  v_lshlrev_b32 v5, 10, v5
  v_and_b32 v6, 1, v1
  v_lshl_add_u32 v5, v6, 4, v5
  s_lshl_b32 s67, s93, 5
  s_mul_i32 s68, s52, 229376
  s_add_u32 s67, s67, s68
  v_add_u32 v167, s67, v5
  v_lshlrev_b32 v5, 3, v1
  v_add_u32 v168, s75, v5
  s_branch L_jj_47
L_jgu_46:
  v_mul_u32_u24 v5, 3584, v1
  s_lshl_b32 s67, s93, 4
  s_mul_i32 s68, s52, 229376
  s_add_u32 s67, s67, s68
  v_add_u32 v167, s67, v5
  v_lshrrev_b32 v6, 4, v1
  v_lshlrev_b32 v6, 2, v6
  v_bfe_u32 v7, v1, 2, 2
  v_add_u32 v6, v6, v7
  v_lshlrev_b32 v6, 4, v6
  v_and_b32 v7, 1, v1
  v_lshl_add_u32 v6, v7, 3, v6
  v_bfe_u32 v7, v1, 1, 1
  v_lshl_add_u32 v6, v7, 10, v6
  v_add_u32 v168, s75, v6
L_jj_47:
  v_and_b32 v5, 31, v1
  s_lshl_b32 s66, s60, 5
  v_add_u32 v5, s66, v5
  v_lshlrev_b32 v5, 10, v5
  v_lshrrev_b32 v6, 5, v1
  v_lshl_add_u32 v5, v6, 5, v5
  s_lshl_b32 s66, s61, 8
  s_lshl_b32 s67, s64, 6
  s_add_u32 s66, s66, s67
  s_lshl_b32 s67, s63, 4
  s_add_u32 s66, s66, s67
  v_add_u32 v161, s66, v5
  s_and_b32 s66, s2, 63
  s_lshl_b32 s66, s66, 7
  s_and_b32 s67, s55, 1
  s_lshl_b32 s67, s67, 13
  s_add_u32 s66, s66, s67
  s_add_u32 s66, s66, 917504
  v_mov_b32 v128, s66
  v_not_b32 v129, s53
  s_waitcnt vmcnt(0) lgkmcnt(0)
  s_barrier
  s_cmp_lg_u32 s52, 2
  s_cbranch_scc1 L_pb_48
  s_lshr_b32 s66, s2, 6
  s_cmp_lg_u32 s66, 1
  s_cbranch_scc1 L_pb_48
  s_mov_b64 exec, 1
  buffer_load_dword v129, v128, s[20:23], 0 offen sc1
  s_mov_b32 s72, 0
L_pbl_49:
  s_add_u32 s72, s72, 1
  v_readfirstlane_b32 s66, v129
  s_cmp_ge_u32 s72, 4096
  s_cbranch_scc1 L_pb_48x
  s_cmp_lg_u32 s66, s53
  s_cbranch_scc1 L_pbl_49
L_pb_48x:
  s_waitcnt vmcnt(0)
  s_mov_b64 exec, -1
L_pb_48:
  s_lshl_b32 s66, s2, 7
  s_add_u32 s66, s66, 32768
  v_mov_b32 v10, s66
  v_mov_b32 v11, s53
  v_cmp_eq_u32 vcc, 0, v0
  s_nop 0
  s_and_saveexec_b64 s[82:83], vcc
  buffer_store_dword v11, v10, s[20:23], 0 offen sc1
  s_mov_b64 exec, s[82:83]
  s_cmp_lg_u32 s52, 1
  s_cbranch_scc1 L_p1b_50
  v_and_b32 v5, 15, v1
  v_lshlrev_b32 v5, 2, v5
  v_add_u32 v5, 154624, v5
  ds_read_b32 v28, v5 offset:0
  ds_read_b32 v29, v5 offset:64
  ds_read_b32 v30, v5 offset:128
  ds_read_b32 v31, v5 offset:192
  ds_read_b32 v32, v5 offset:256
  ds_read_b32 v33, v5 offset:320
  ds_read_b32 v34, v5 offset:384
  ds_read_b32 v35, v5 offset:448
  s_waitcnt lgkmcnt(0)
  v_add_f32 v28, v28, v29
  v_add_f32 v30, v30, v31
  v_add_f32 v32, v32, v33
  v_add_f32 v34, v34, v35
  v_add_f32 v28, v28, v30
  v_add_f32 v32, v32, v34
  v_add_f32 v24, v28, v32
  v_cvt_pk_bf16_f32 v24, v24, v24
  v_lshlrev_b32 v24, 16, v24
  s_sub_u32 s66, s62, 128
  s_cmp_ge_u32 s66, 64
  s_cbranch_scc1 L_p1bn_51
  v_add_f32 v24, 1.0, v24
  v_cvt_pk_bf16_f32 v24, v24, v24
  v_lshlrev_b32 v24, 16, v24
L_p1bn_51:
  v_mov_b32 v25, s53
  s_lshl_b32 s67, s62, 7
  s_add_u32 s67, s67, 65536
  v_lshlrev_b32 v3, 3, v1
  v_add_u32 v3, s67, v3
  s_mov_b64 exec, 0xff
  buffer_store_dwordx2 v[24:25], v3, s[20:23], 0 offen sc1
  s_mov_b64 exec, -1
L_p1b_50:
  v_and_b32 v10, 15, v1
  v_lshrrev_b32 v12, 2, v10
  v_and_b32 v10, 3, v10
  s_lshr_b32 s66, s58, 1
  s_and_b32 s67, s66, 7
  s_lshl_b32 s67, s67, 2
  v_add_u32 v10, s67, v10
  v_lshlrev_b32 v10, 3, v10
  s_lshr_b32 s66, s66, 3
  s_lshl_b32 s66, s66, 2
  v_add_u32 v10, s66, v10
  v_add_u32 v10, v10, v12
  v_lshlrev_b32 v10, 7, v10
  v_add_u32 v10, 32768, v10
  s_lshl_b32 s99, s64, 1
  s_add_u32 s99, s99, s63
  s_lshl_b32 s71, s59, 3
  s_add_u32 s99, s99, s71
  s_lshl_b32 s71, s58, 16
  v_lshlrev_b32 v5, 4, v1
  v_add_u32 v164, s71, v5
  s_lshl_b32 s71, s63, 15
  v_add_u32 v162, s71, v5
  v_and_b32 v163, 15, v1
  v_lshlrev_b32 v163, 4, v163
  v_lshrrev_b32 v6, 5, v1
  v_lshl_add_u32 v163, v6, 8, v163
  s_add_u32 s71, s71, 65536
  v_add_u32 v163, s71, v163
  v_and_b32 v6, 0x33, v1
  v_bfe_u32 v7, v1, 2, 1
  v_lshl_or_b32 v6, v7, 3, v6
  v_bfe_u32 v7, v1, 3, 1
  v_lshl_or_b32 v6, v7, 2, v6
  s_lshl_b32 s71, s63, 15
  v_lshl_add_u32 v162, v6, 4, s71
  v_mov_b32 v170, 0xdddddddd
  v_mov_b32 v16, 0
  v_mov_b32 v32, 0
  v_mov_b32 v17, 0
  v_mov_b32 v33, 0
  v_mov_b32 v18, 0
  v_mov_b32 v34, 0
  v_mov_b32 v19, 0
  v_mov_b32 v35, 0
  v_mov_b32 v20, 0
  v_mov_b32 v36, 0
  v_mov_b32 v21, 0
  v_mov_b32 v37, 0
  v_mov_b32 v22, 0
  v_mov_b32 v38, 0
  v_mov_b32 v23, 0
  v_mov_b32 v39, 0
  v_mov_b32 v24, 0
  v_mov_b32 v40, 0
  v_mov_b32 v25, 0
  v_mov_b32 v41, 0
  v_mov_b32 v26, 0
  v_mov_b32 v42, 0
  v_mov_b32 v27, 0
  v_mov_b32 v43, 0
  v_mov_b32 v28, 0
  v_mov_b32 v44, 0
  v_mov_b32 v29, 0
  v_mov_b32 v45, 0
  v_mov_b32 v30, 0
  v_mov_b32 v46, 0
  v_mov_b32 v31, 0
  v_mov_b32 v47, 0
  v_mov_b32 v172, -1
  v_mov_b32 v173, -1
  v_mov_b32 v174, -1
  v_mov_b32 v175, -1
  s_lshl_b32 s71, s60, 12
  s_add_u32 s71, s71, 7864320
  v_and_b32 v6, 31, v1
  v_lshl_add_u32 v171, v6, 7, s71
  s_sub_u32 s71, s52, 1
  s_lshl_b32 s71, s71, 6
  s_and_b32 s71, s71, 64
  v_add_u32 v6, s71, v1
  s_lshl_b32 s71, s61, 7
  v_add_u32 v7, s71, v6
  v_lshrrev_b32 v6, 3, v7
  v_and_b32 v7, 7, v7
  v_lshlrev_b32 v7, 3, v7
  v_lshl_add_u32 v7, v6, 7, v7
  v_add_u32 v248, 65536, v7
  v_and_b32 v6, 27, v1
  v_cmp_eq_u32 vcc, 16, v6
  v_mov_b32 v7, 0x3f803f80
  s_nop 0
  v_cndmask_b32 v112, 0, v7, vcc
  v_mov_b32 v113, v112
  v_mov_b32 v114, v112
  v_mov_b32 v115, v112
  v_mov_b32 v116, v112
  v_mov_b32 v117, v112
  v_mov_b32 v118, v112
  v_mov_b32 v119, v112
  v_mov_b32 v120, v112
  v_mov_b32 v121, v112
  v_mov_b32 v122, v112
  v_mov_b32 v123, v112
  v_mov_b32 v124, v112
  v_mov_b32 v125, v112
  v_mov_b32 v126, v112
  v_mov_b32 v127, v112
  s_lshl_b32 s78, s63, 15
  s_lshl_b32 s71, s64, 10
  s_add_u32 s78, s78, s71
  s_cmp_lg_u32 s52, 0
  s_cbranch_scc1 L_pfd_53
  s_mov_b64 exec, 65535
L_pf_52:
  buffer_load_dword v11, v10, s[20:23], 0 offen sc1
  s_waitcnt vmcnt(0)
  v_cmp_eq_u32 vcc, s53, v11
  s_nop 0
  s_cmp_eq_u64 vcc, exec
  s_cbranch_scc1 L_pfd_53x
  s_cmp_eq_u32 s81, 0
  s_cbranch_scc1 L_pfd_53x
  s_sub_u32 s81, s81, 1
  s_branch L_pf_52
L_pfd_53x:
  s_mov_b64 exec, -1
L_pfd_53:
  s_barrier
  s_add_u32 m0, s78, 0
  s_add_u32 s66, s78, 3145728
  buffer_load_dwordx4 v164, s[20:23], s66 offen sc1 lds
  s_add_u32 m0, s78, 65536
  s_add_u32 s66, s78, 5242880
  buffer_load_dwordx4 v164, s[20:23], s66 offen sc1 lds
  s_xor_b32 s66, s99, 0
  s_lshl_b32 s66, s66, 10
  s_add_u32 s66, s66, 1048576
  buffer_load_dwordx4 v[96:99], v164, s[20:23], s66 offen sc1
  s_xor_b32 s66, s99, 1
  s_lshl_b32 s66, s66, 10
  s_add_u32 s66, s66, 1048576
  buffer_load_dwordx4 v[100:103], v164, s[20:23], s66 offen sc1
  s_lshl_b32 s66, s61, 8
  v_and_b32 v6, 127, v0
  v_xor_b32 v6, 64, v6
  v_lshl_add_u32 v160, v6, 1, s66
  v_lshlrev_b32 v9, 4, v1
  v_add_u32 v5, s95, v9
  v_lshlrev_b32 v6, 2, v1
  v_add_u32 v6, s95, v6
  v_xor_b32 v7, 16384, v5
  v_xor_b32 v8, 16384, v6
  s_lshl_b32 s77, s99, 5
  s_add_u32 s77, s77, s58
  s_lshl_b32 s77, s77, 7
  s_add_u32 s77, s77, 7864320
  v_mov_b32 v12, s77
  v_mov_b32 v13, s53
  v_mov_b32 v10, 0x71800000
  v_mov_b32 v11, 0x7f800000
  s_cmp_eq_u32 s63, 1
  s_cselect_b64 vcc, -1, 0
  v_lshlrev_b32 v130, 5, v1
  v_add_u32 v130, 851968, v130
  s_waitcnt vmcnt(0)
  s_barrier
  ds_read_b128 v[104:107], v162 offset:0
  ds_read_b128 v[108:111], v162 offset:1024
  s_mov_b64 exec, s[84:85]
  ds_read_b128 v[112:115], v163 offset:0
  ds_read_b128 v[116:119], v163 offset:512
  ds_read_b128 v[120:123], v163 offset:1024
  ds_read_b128 v[124:127], v163 offset:1536
  s_mov_b64 exec, -1
  s_waitcnt lgkmcnt(5)
  v_mfma_f32_32x32x16_bf16 v[48:63], v[104:107], v[96:99], 0
  v_mfma_f32_32x32x16_bf16 v[64:79], v[104:107], v[100:103], 0
  s_cbranch_vccz L_pr_54
  s_setprio 1
L_pr_54:
  s_nop 9
  v_exp_f32 v48, v48
  v_exp_f32 v49, v49
  v_exp_f32 v50, v50
  s_add_u32 m0, s78, 4096
  s_add_u32 s66, s78, 3149824
  buffer_load_dwordx4 v164, s[20:23], s66 offen sc1 lds
  v_exp_f32 v51, v51
  v_exp_f32 v52, v52
  s_add_u32 m0, s78, 69632
  s_add_u32 s66, s78, 5246976
  buffer_load_dwordx4 v164, s[20:23], s66 offen sc1 lds
  v_exp_f32 v53, v53
  v_exp_f32 v54, v54
  v_exp_f32 v55, v55
  v_exp_f32 v56, v56
  v_exp_f32 v57, v57
  v_exp_f32 v58, v58
  v_exp_f32 v59, v59
  v_exp_f32 v60, v60
  v_exp_f32 v61, v61
  v_exp_f32 v62, v62
  s_cmp_lg_u32 s52, 2
  s_cbranch_scc1 L_pr_70
  s_lshr_b32 s66, s2, 6
  s_cmp_lg_u32 s66, 1
  s_cbranch_scc1 L_pr_70
  v_mov_b32 v132, s72
  v_mov_b32 v133, s53
  s_and_b32 s67, s2, 63
  s_lshl_b32 s67, s67, 5
  s_add_u32 s67, s67, 851968
  v_mov_b32 v134, s67
  s_mov_b64 exec, 1
  buffer_store_dwordx2 v[132:133], v134, s[20:23], 0 offen sc1
  s_mov_b64 exec, -1
L_pr_70:
  v_exp_f32 v63, v63
  s_waitcnt lgkmcnt(4)
  v_mfma_f32_32x32x16_bf16 v[80:95], v[108:111], v[96:99], 0
  v_exp_f32 v64, v64
  v_exp_f32 v65, v65
  v_exp_f32 v66, v66
  s_add_u32 m0, s89, 8192
  s_add_u32 s66, s65, 8192
  buffer_load_dwordx4 v164, s[20:23], s66 offen sc1 lds
  v_exp_f32 v67, v67
  s_waitcnt lgkmcnt(2)
  v_smfmac_f32_32x32x32_bf16 v[16:31], v[112:115], v[48:55], v170
  v_exp_f32 v68, v68
  s_add_u32 m0, s89, 73728
  s_add_u32 s66, s65, 2105344
  buffer_load_dwordx4 v164, s[20:23], s66 offen sc1 lds
  v_exp_f32 v69, v69
  v_exp_f32 v70, v70
  v_exp_f32 v71, v71
  v_smfmac_f32_32x32x32_bf16 v[16:31], v[116:119], v[56:63], v170
  v_exp_f32 v72, v72
  v_exp_f32 v73, v73
  v_exp_f32 v74, v74
  ds_read_b128 v[104:107], v162 offset:2048
  v_exp_f32 v75, v75
  v_exp_f32 v76, v76
  v_exp_f32 v77, v77
  v_exp_f32 v78, v78
  v_exp_f32 v79, v79
  v_mfma_f32_32x32x16_bf16 v[48:63], v[108:111], v[100:103], 0
  v_exp_f32 v80, v80
  v_exp_f32 v81, v81
  v_exp_f32 v82, v82
  s_add_u32 m0, s89, 40960
  s_add_u32 s66, s65, 40960
  buffer_load_dwordx4 v164, s[20:23], s66 offen sc1 lds
  v_exp_f32 v83, v83
  v_smfmac_f32_32x32x32_bf16 v[32:47], v[112:115], v[64:71], v170
  v_exp_f32 v84, v84
  s_add_u32 m0, s89, 106496
  s_add_u32 s66, s65, 2138112
  buffer_load_dwordx4 v164, s[20:23], s66 offen sc1 lds
  v_exp_f32 v85, v85
  v_exp_f32 v86, v86
  v_exp_f32 v87, v87
  v_smfmac_f32_32x32x32_bf16 v[32:47], v[116:119], v[72:79], v170
  v_exp_f32 v88, v88
  v_exp_f32 v89, v89
  v_exp_f32 v90, v90
  s_mov_b64 exec, s[84:85]
  ds_read_b128 v[112:115], v163 offset:2048
  ds_read_b128 v[116:119], v163 offset:2560
  s_mov_b64 exec, -1
  v_exp_f32 v91, v91
  v_exp_f32 v92, v92
  v_exp_f32 v93, v93
  v_exp_f32 v94, v94
  v_exp_f32 v95, v95
  s_waitcnt lgkmcnt(2)
  v_mfma_f32_32x32x16_bf16 v[64:79], v[104:107], v[96:99], 0
  s_setprio 0
  v_exp_f32 v48, v48
  v_exp_f32 v49, v49
  v_exp_f32 v50, v50
  s_add_u32 m0, s95, 0
  s_mov_b32 s66, 0
  buffer_load_dwordx4 v165, s[16:19], s66 offen lds
  v_exp_f32 v51, v51
  v_smfmac_f32_32x32x32_bf16 v[16:31], v[120:123], v[80:87], v170
  v_exp_f32 v52, v52
  s_add_u32 m0, s95, 1024
  s_mov_b32 s66, 16384
  buffer_load_dwordx4 v165, s[16:19], s66 offen lds
  v_exp_f32 v53, v53
  v_exp_f32 v54, v54
  v_exp_f32 v55, v55
  v_smfmac_f32_32x32x32_bf16 v[16:31], v[124:127], v[88:95], v170
  v_exp_f32 v56, v56
  v_exp_f32 v57, v57
  v_exp_f32 v58, v58
  ds_read_b128 v[108:111], v162 offset:3072
  v_exp_f32 v59, v59
  v_exp_f32 v60, v60
  v_exp_f32 v61, v61
  v_exp_f32 v62, v62
  v_exp_f32 v63, v63
  v_mfma_f32_32x32x16_bf16 v[80:95], v[104:107], v[100:103], 0
  s_cbranch_vccz L_pr_55
  s_setprio 1
L_pr_55:
  v_exp_f32 v64, v64
  v_exp_f32 v65, v65
  v_exp_f32 v66, v66
  s_add_u32 m0, s95, 2048
  s_mov_b32 s66, 32768
  buffer_load_dwordx4 v165, s[16:19], s66 offen lds
  v_exp_f32 v67, v67
  v_smfmac_f32_32x32x32_bf16 v[32:47], v[120:123], v[48:55], v170
  v_exp_f32 v68, v68
  s_add_u32 m0, s95, 3072
  s_mov_b32 s66, 49152
  buffer_load_dwordx4 v165, s[16:19], s66 offen lds
  v_exp_f32 v69, v69
  v_exp_f32 v70, v70
  v_exp_f32 v71, v71
  v_smfmac_f32_32x32x32_bf16 v[32:47], v[124:127], v[56:63], v170
  v_exp_f32 v72, v72
  v_exp_f32 v73, v73
  v_exp_f32 v74, v74
  s_mov_b64 exec, s[84:85]
  ds_read_b128 v[120:123], v163 offset:3072
  ds_read_b128 v[124:127], v163 offset:3584
  s_mov_b64 exec, -1
  v_exp_f32 v75, v75
  v_exp_f32 v76, v76
  v_exp_f32 v77, v77
  v_exp_f32 v78, v78
  s_waitcnt vmcnt(8)
  s_barrier
  v_exp_f32 v79, v79
  s_waitcnt lgkmcnt(2)
  v_mfma_f32_32x32x16_bf16 v[48:63], v[108:111], v[96:99], 0
  v_exp_f32 v80, v80
  v_exp_f32 v81, v81
  v_exp_f32 v82, v82
  s_add_u32 m0, s89, 16384
  s_add_u32 s66, s65, 16384
  buffer_load_dwordx4 v164, s[20:23], s66 offen sc1 lds
  v_exp_f32 v83, v83
  v_smfmac_f32_32x32x32_bf16 v[16:31], v[112:115], v[64:71], v170
  v_exp_f32 v84, v84
  s_add_u32 m0, s89, 81920
  s_add_u32 s66, s65, 2113536
  buffer_load_dwordx4 v164, s[20:23], s66 offen sc1 lds
  v_exp_f32 v85, v85
  v_exp_f32 v86, v86
  v_exp_f32 v87, v87
  v_smfmac_f32_32x32x32_bf16 v[16:31], v[116:119], v[72:79], v170
  v_exp_f32 v88, v88
  v_exp_f32 v89, v89
  v_exp_f32 v90, v90
  ds_read_b128 v[104:107], v162 offset:4096
  v_exp_f32 v91, v91
  v_exp_f32 v92, v92
  v_exp_f32 v93, v93
  v_exp_f32 v94, v94
  v_exp_f32 v95, v95
  v_mfma_f32_32x32x16_bf16 v[64:79], v[108:111], v[100:103], 0
  v_exp_f32 v48, v48
  v_exp_f32 v49, v49
  v_exp_f32 v50, v50
  s_add_u32 m0, s89, 49152
  s_add_u32 s66, s65, 49152
  buffer_load_dwordx4 v164, s[20:23], s66 offen sc1 lds
  v_exp_f32 v51, v51
  v_smfmac_f32_32x32x32_bf16 v[32:47], v[112:115], v[80:87], v170
  v_exp_f32 v52, v52
  s_add_u32 m0, s89, 114688
  s_add_u32 s66, s65, 2146304
  buffer_load_dwordx4 v164, s[20:23], s66 offen sc1 lds
  v_exp_f32 v53, v53
  v_exp_f32 v54, v54
  v_exp_f32 v55, v55
  v_smfmac_f32_32x32x32_bf16 v[32:47], v[116:119], v[88:95], v170
  v_exp_f32 v56, v56
  v_exp_f32 v57, v57
  v_exp_f32 v58, v58
  s_mov_b64 exec, s[84:85]
  ds_read_b128 v[112:115], v163 offset:4096
  ds_read_b128 v[116:119], v163 offset:4608
  s_mov_b64 exec, -1
  v_exp_f32 v59, v59
  v_exp_f32 v60, v60
  v_exp_f32 v61, v61
  v_exp_f32 v62, v62
  v_exp_f32 v63, v63
  s_waitcnt lgkmcnt(2)
  v_mfma_f32_32x32x16_bf16 v[80:95], v[104:107], v[96:99], 0
  s_setprio 0
  v_exp_f32 v64, v64
  v_exp_f32 v65, v65
  v_exp_f32 v66, v66
  s_add_u32 m0, s89, 24576
  s_add_u32 s66, s65, 24576
  buffer_load_dwordx4 v164, s[20:23], s66 offen sc1 lds
  v_exp_f32 v67, v67
  v_smfmac_f32_32x32x32_bf16 v[16:31], v[120:123], v[48:55], v170
  v_exp_f32 v68, v68
  s_add_u32 m0, s89, 90112
  s_add_u32 s66, s65, 2121728
  buffer_load_dwordx4 v164, s[20:23], s66 offen sc1 lds
  v_exp_f32 v69, v69
  v_exp_f32 v70, v70
  v_exp_f32 v71, v71
  v_smfmac_f32_32x32x32_bf16 v[16:31], v[124:127], v[56:63], v170
  v_exp_f32 v72, v72
  v_exp_f32 v73, v73
  v_exp_f32 v74, v74
  ds_read_b128 v[108:111], v162 offset:5120
  v_exp_f32 v75, v75
  v_exp_f32 v76, v76
  v_exp_f32 v77, v77
  v_exp_f32 v78, v78
  v_exp_f32 v79, v79
  v_mfma_f32_32x32x16_bf16 v[48:63], v[104:107], v[100:103], 0
  s_cbranch_vccz L_pr_56
  s_setprio 1
L_pr_56:
  v_exp_f32 v80, v80
  v_exp_f32 v81, v81
  v_exp_f32 v82, v82
  s_add_u32 m0, s89, 57344
  s_add_u32 s66, s65, 57344
  buffer_load_dwordx4 v164, s[20:23], s66 offen sc1 lds
  v_exp_f32 v83, v83
  v_smfmac_f32_32x32x32_bf16 v[32:47], v[120:123], v[64:71], v170
  v_exp_f32 v84, v84
  s_add_u32 m0, s89, 122880
  s_add_u32 s66, s65, 2154496
  buffer_load_dwordx4 v164, s[20:23], s66 offen sc1 lds
  v_exp_f32 v85, v85
  v_exp_f32 v86, v86
  v_exp_f32 v87, v87
  v_smfmac_f32_32x32x32_bf16 v[32:47], v[124:127], v[72:79], v170
  v_exp_f32 v88, v88
  v_exp_f32 v89, v89
  v_exp_f32 v90, v90
  s_mov_b64 exec, s[84:85]
  ds_read_b128 v[120:123], v163 offset:5120
  ds_read_b128 v[124:127], v163 offset:5632
  s_mov_b64 exec, -1
  v_exp_f32 v91, v91
  v_exp_f32 v92, v92
  v_exp_f32 v93, v93
  v_exp_f32 v94, v94
  v_exp_f32 v95, v95
  s_waitcnt lgkmcnt(2)
  v_mfma_f32_32x32x16_bf16 v[64:79], v[108:111], v[96:99], 0
  v_exp_f32 v48, v48
  v_exp_f32 v49, v49
  v_exp_f32 v50, v50
  v_exp_f32 v51, v51
  v_smfmac_f32_32x32x32_bf16 v[16:31], v[112:115], v[80:87], v170
  v_exp_f32 v52, v52
  v_exp_f32 v53, v53
  v_exp_f32 v54, v54
  v_exp_f32 v55, v55
  v_smfmac_f32_32x32x32_bf16 v[16:31], v[116:119], v[88:95], v170
  v_exp_f32 v56, v56
  v_exp_f32 v57, v57
  v_exp_f32 v58, v58
  ds_read_b128 v[104:107], v162 offset:6144
  v_exp_f32 v59, v59
  v_exp_f32 v60, v60
  v_exp_f32 v61, v61
  v_exp_f32 v62, v62
  v_exp_f32 v63, v63
  v_mfma_f32_32x32x16_bf16 v[80:95], v[108:111], v[100:103], 0
  v_exp_f32 v64, v64
  v_exp_f32 v65, v65
  v_exp_f32 v66, v66
  s_waitcnt vmcnt(8)
  ds_read_b64_tr_b16 v[176:177], v166 offset:0
  ds_read_b64_tr_b16 v[178:179], v166 offset:512
  v_exp_f32 v67, v67
  v_smfmac_f32_32x32x32_bf16 v[32:47], v[112:115], v[48:55], v170
  v_exp_f32 v68, v68
  ds_read_b64_tr_b16 v[180:181], v166 offset:1024
  ds_read_b64_tr_b16 v[182:183], v166 offset:1536
  v_exp_f32 v69, v69
  v_exp_f32 v70, v70
  v_exp_f32 v71, v71
  v_smfmac_f32_32x32x32_bf16 v[32:47], v[116:119], v[56:63], v170
  v_exp_f32 v72, v72
  v_exp_f32 v73, v73
  v_exp_f32 v74, v74
  s_mov_b64 exec, s[84:85]
  ds_read_b128 v[112:115], v163 offset:6144
  ds_read_b128 v[116:119], v163 offset:6656
  s_mov_b64 exec, -1
  v_exp_f32 v75, v75
  v_exp_f32 v76, v76
  v_exp_f32 v77, v77
  v_exp_f32 v78, v78
  v_exp_f32 v79, v79
  s_waitcnt lgkmcnt(6)
  v_mfma_f32_32x32x16_bf16 v[48:63], v[104:107], v[96:99], 0
  s_setprio 0
  v_exp_f32 v80, v80
  v_exp_f32 v81, v81
  v_exp_f32 v82, v82
  ds_read_b64_tr_b16 v[184:185], v166 offset:2048
  ds_read_b64_tr_b16 v[186:187], v166 offset:2560
  v_exp_f32 v83, v83
  v_smfmac_f32_32x32x32_bf16 v[16:31], v[120:123], v[64:71], v170
  v_exp_f32 v84, v84
  ds_read_b64_tr_b16 v[188:189], v166 offset:3072
  ds_read_b64_tr_b16 v[190:191], v166 offset:3584
  v_exp_f32 v85, v85
  v_exp_f32 v86, v86
  v_exp_f32 v87, v87
  v_smfmac_f32_32x32x32_bf16 v[16:31], v[124:127], v[72:79], v170
  v_exp_f32 v88, v88
  v_exp_f32 v89, v89
  v_exp_f32 v90, v90
  ds_read_b128 v[108:111], v162 offset:7168
  v_exp_f32 v91, v91
  v_exp_f32 v92, v92
  v_exp_f32 v93, v93
  v_exp_f32 v94, v94
  v_exp_f32 v95, v95
  v_mfma_f32_32x32x16_bf16 v[64:79], v[104:107], v[100:103], 0
  s_barrier
  s_cbranch_vccz L_pr_57
  s_setprio 1
L_pr_57:
  v_exp_f32 v48, v48
  v_exp_f32 v49, v49
  s_waitcnt lgkmcnt(1)
  v_exp_f32 v50, v50
  s_add_u32 m0, s95, 0
  s_mov_b32 s66, 65536
  buffer_load_dwordx4 v165, s[16:19], s66 offen lds
  v_exp_f32 v51, v51
  v_smfmac_f32_32x32x32_bf16 v[32:47], v[120:123], v[80:87], v170
  v_exp_f32 v52, v52
  s_add_u32 m0, s95, 1024
  s_mov_b32 s66, 81920
  buffer_load_dwordx4 v165, s[16:19], s66 offen lds
  v_exp_f32 v53, v53
  v_exp_f32 v54, v54
  v_exp_f32 v55, v55
  v_smfmac_f32_32x32x32_bf16 v[32:47], v[124:127], v[88:95], v170
  v_exp_f32 v56, v56
  v_exp_f32 v57, v57
  v_exp_f32 v58, v58
  s_mov_b64 exec, s[84:85]
  ds_read_b128 v[120:123], v163 offset:7168
  ds_read_b128 v[124:127], v163 offset:7680
  s_mov_b64 exec, -1
  v_exp_f32 v59, v59
  v_exp_f32 v60, v60
  v_exp_f32 v61, v61
  buffer_load_dwordx2 v[128:129], v130, s[20:23], 0 offen
  v_exp_f32 v62, v62
  v_exp_f32 v63, v63
  s_waitcnt lgkmcnt(2)
  v_mfma_f32_32x32x16_bf16 v[80:95], v[108:111], v[96:99], 0
  v_exp_f32 v64, v64
  v_exp_f32 v65, v65
  v_exp_f32 v66, v66
  s_add_u32 m0, s95, 2048
  s_mov_b32 s66, 98304
  buffer_load_dwordx4 v165, s[16:19], s66 offen lds
  v_exp_f32 v67, v67
  v_smfmac_f32_32x32x32_bf16 v[16:31], v[112:115], v[48:55], v170
  v_exp_f32 v68, v68
  s_add_u32 m0, s95, 3072
  s_mov_b32 s66, 114688
  buffer_load_dwordx4 v165, s[16:19], s66 offen lds
  v_exp_f32 v69, v69
  v_exp_f32 v70, v70
  v_exp_f32 v71, v71
  v_smfmac_f32_32x32x32_bf16 v[16:31], v[116:119], v[56:63], v170
  v_exp_f32 v72, v72
  v_exp_f32 v73, v73
  v_exp_f32 v74, v74
  ds_read_b128 v[104:107], v162 offset:8192
  v_exp_f32 v75, v75
  v_exp_f32 v76, v76
  v_exp_f32 v77, v77
  v_exp_f32 v78, v78
  v_exp_f32 v79, v79
  v_mfma_f32_32x32x16_bf16 v[48:63], v[108:111], v[100:103], 0
  v_exp_f32 v80, v80
  v_exp_f32 v81, v81
  v_exp_f32 v82, v82
  v_exp_f32 v83, v83
  v_smfmac_f32_32x32x32_bf16 v[32:47], v[112:115], v[64:71], v170
  v_exp_f32 v84, v84
  v_exp_f32 v85, v85
  v_exp_f32 v86, v86
  v_exp_f32 v87, v87
  v_smfmac_f32_32x32x32_bf16 v[32:47], v[116:119], v[72:79], v170
  v_exp_f32 v88, v88
  v_exp_f32 v89, v89
  v_exp_f32 v90, v90
  s_mov_b64 exec, s[84:85]
  ds_read_b128 v[112:115], v163 offset:8192
  ds_read_b128 v[116:119], v163 offset:8704
  s_mov_b64 exec, -1
  v_exp_f32 v91, v91
  v_exp_f32 v92, v92
  v_exp_f32 v93, v93
  v_exp_f32 v94, v94
  v_exp_f32 v95, v95
  s_waitcnt lgkmcnt(2)
  v_mfma_f32_32x32x16_bf16 v[64:79], v[104:107], v[96:99], 0
  s_setprio 0
  v_exp_f32 v48, v48
  v_exp_f32 v49, v49
  v_exp_f32 v50, v50
  v_exp_f32 v51, v51
  v_smfmac_f32_32x32x32_bf16 v[16:31], v[120:123], v[80:87], v170
  v_exp_f32 v52, v52
  v_exp_f32 v53, v53
  v_exp_f32 v54, v54
  buffer_load_dwordx4 v[156:159], v161, s[8:11], 0 offen
  v_exp_f32 v55, v55
  v_smfmac_f32_32x32x32_bf16 v[16:31], v[124:127], v[88:95], v170
  v_exp_f32 v56, v56
  v_exp_f32 v57, v57
  v_exp_f32 v58, v58
  ds_read_b128 v[108:111], v162 offset:9216
  v_exp_f32 v59, v59
  v_exp_f32 v60, v60
  v_exp_f32 v61, v61
  v_exp_f32 v62, v62
  v_exp_f32 v63, v63
  v_mfma_f32_32x32x16_bf16 v[80:95], v[104:107], v[100:103], 0
  s_cbranch_vccz L_pr_58
  s_setprio 1
L_pr_58:
  v_exp_f32 v64, v64
  v_exp_f32 v65, v65
  v_exp_f32 v66, v66
  v_exp_f32 v67, v67
  v_smfmac_f32_32x32x32_bf16 v[32:47], v[120:123], v[48:55], v170
  v_exp_f32 v68, v68
  v_exp_f32 v69, v69
  v_exp_f32 v70, v70
  buffer_load_ushort v160, v160, s[36:39], 0 offen
  v_exp_f32 v71, v71
  v_smfmac_f32_32x32x32_bf16 v[32:47], v[124:127], v[56:63], v170
  v_exp_f32 v72, v72
  v_exp_f32 v73, v73
  v_exp_f32 v74, v74
  s_mov_b64 exec, s[84:85]
  ds_read_b128 v[120:123], v163 offset:9216
  ds_read_b128 v[124:127], v163 offset:9728
  s_mov_b64 exec, -1
  v_exp_f32 v75, v75
  v_exp_f32 v76, v76
  v_exp_f32 v77, v77
  s_waitcnt vmcnt(4)
L_vc_71:
  v_cmp_eq_u32 s[68:69], s53, v129
  s_nop 0
  s_cmp_eq_u64 s[68:69], exec
  s_cbranch_scc1 L_vcd_72
  buffer_load_dwordx2 v[128:129], v130, s[20:23], 0 offen sc1
  s_waitcnt vmcnt(0)
  s_cmp_eq_u32 s81, 0
  s_cbranch_scc1 L_vcd_72
  s_sub_u32 s81, s81, 1
  s_branch L_vc_71
L_vcd_72:
  v_mov_b32_dpp v131, v128 row_ror:8 row_mask:0xf bank_mask:0xf
  s_nop 0
  v_cmp_lt_u32 s[68:69], v128, v131
  s_nop 1
  s_andn2_b32 s66, 0x000f000f, s68
  s_andn2_b32 s67, 0x000f000f, s69
  s_and_b32 s68, 0x00f000f0, s68
  s_and_b32 s69, 0x00f000f0, s69
  s_or_b32 s68, s68, s66
  s_or_b32 s69, s69, s67
  s_bcnt1_i32_b64 s66, s[68:69]
  s_cmp_gt_u32 s66, 16
  s_cselect_b32 s0, 8192, 0
  s_mov_b32 s1, s0
  s_and_b32 s76, s99, 31
  s_lshl_b32 s76, s76, 16
  s_lshr_b32 s77, s99, 5
  s_lshl_b32 s77, s77, 13
  s_xor_b32 s77, s77, s1
  s_add_u32 s76, s76, s77
  s_add_u32 s76, s76, 8388608
  s_lshr_b32 s77, s58, 3
  s_lshl_b32 s77, s77, 14
  s_add_u32 s76, s76, s77
  s_and_b32 s77, s58, 7
  s_lshl_b32 s77, s77, 10
  s_add_u32 s76, s76, s77
  v_exp_f32 v78, v78
  v_exp_f32 v79, v79
  s_waitcnt lgkmcnt(2)
  v_mfma_f32_32x32x16_bf16 v[48:63], v[108:111], v[96:99], 0
  v_exp_f32 v80, v80
  v_exp_f32 v81, v81
  v_exp_f32 v82, v82
  v_exp_f32 v83, v83
  v_smfmac_f32_32x32x32_bf16 v[16:31], v[112:115], v[64:71], v170
  v_exp_f32 v84, v84
  v_exp_f32 v85, v85
  v_exp_f32 v86, v86
  v_exp_f32 v87, v87
  v_smfmac_f32_32x32x32_bf16 v[16:31], v[116:119], v[72:79], v170
  v_exp_f32 v88, v88
  v_exp_f32 v89, v89
  v_exp_f32 v90, v90
  ds_read_b128 v[104:107], v162 offset:10240
  v_exp_f32 v91, v91
  v_exp_f32 v92, v92
  v_exp_f32 v93, v93
  buffer_store_dwordx4 v[172:175], v9, s[20:23], s76 offen sc1
  v_exp_f32 v94, v94
  v_exp_f32 v95, v95
  v_mfma_f32_32x32x16_bf16 v[64:79], v[108:111], v[100:103], 0
  v_exp_f32 v48, v48
  v_exp_f32 v49, v49
  v_exp_f32 v50, v50
  v_exp_f32 v51, v51
  v_smfmac_f32_32x32x32_bf16 v[32:47], v[112:115], v[80:87], v170
  v_exp_f32 v52, v52
  v_exp_f32 v53, v53
  v_exp_f32 v54, v54
  v_exp_f32 v55, v55
  v_smfmac_f32_32x32x32_bf16 v[32:47], v[116:119], v[88:95], v170
  v_exp_f32 v56, v56
  v_exp_f32 v57, v57
  v_exp_f32 v58, v58
  s_mov_b64 exec, s[84:85]
  ds_read_b128 v[112:115], v163 offset:10240
  ds_read_b128 v[116:119], v163 offset:10752
  s_mov_b64 exec, -1
  v_exp_f32 v59, v59
  v_exp_f32 v60, v60
  v_exp_f32 v61, v61
  v_exp_f32 v62, v62
  v_exp_f32 v63, v63
  s_waitcnt lgkmcnt(2)
  v_mfma_f32_32x32x16_bf16 v[80:95], v[104:107], v[96:99], 0
  s_setprio 0
  v_exp_f32 v64, v64
  v_exp_f32 v65, v65
  v_exp_f32 v66, v66
  v_exp_f32 v67, v67
  v_smfmac_f32_32x32x32_bf16 v[16:31], v[120:123], v[48:55], v170
  v_exp_f32 v68, v68
  v_exp_f32 v69, v69
  v_exp_f32 v70, v70
  v_exp_f32 v71, v71
  v_smfmac_f32_32x32x32_bf16 v[16:31], v[124:127], v[56:63], v170
  v_exp_f32 v72, v72
  v_exp_f32 v73, v73
  v_exp_f32 v74, v74
  ds_read_b128 v[108:111], v162 offset:11264
  v_exp_f32 v75, v75
  v_exp_f32 v76, v76
  v_exp_f32 v77, v77
  v_exp_f32 v78, v78
  v_exp_f32 v79, v79
  v_mfma_f32_32x32x16_bf16 v[48:63], v[104:107], v[100:103], 0
  s_cbranch_vccz L_pr_59
  s_setprio 1
L_pr_59:
  v_exp_f32 v80, v80
  v_exp_f32 v81, v81
  v_exp_f32 v82, v82
  s_waitcnt vmcnt(3)
  ds_read_b64_tr_b16 v[192:193], v166 offset:0
  ds_read_b64_tr_b16 v[194:195], v166 offset:512
  v_exp_f32 v83, v83
  v_smfmac_f32_32x32x32_bf16 v[32:47], v[120:123], v[64:71], v170
  v_exp_f32 v84, v84
  ds_read_b64_tr_b16 v[196:197], v166 offset:1024
  ds_read_b64_tr_b16 v[198:199], v166 offset:1536
  v_exp_f32 v85, v85
  v_exp_f32 v86, v86
  v_exp_f32 v87, v87
  v_smfmac_f32_32x32x32_bf16 v[32:47], v[124:127], v[72:79], v170
  v_exp_f32 v88, v88
  v_exp_f32 v89, v89
  v_exp_f32 v90, v90
  s_mov_b64 exec, s[84:85]
  ds_read_b128 v[120:123], v163 offset:11264
  ds_read_b128 v[124:127], v163 offset:11776
  s_mov_b64 exec, -1
  v_exp_f32 v91, v91
  v_exp_f32 v92, v92
  v_exp_f32 v93, v93
  v_exp_f32 v94, v94
  v_exp_f32 v95, v95
  s_waitcnt lgkmcnt(6)
  v_mfma_f32_32x32x16_bf16 v[64:79], v[108:111], v[96:99], 0
  v_exp_f32 v48, v48
  v_exp_f32 v49, v49
  v_exp_f32 v50, v50
  ds_read_b64_tr_b16 v[200:201], v166 offset:2048
  ds_read_b64_tr_b16 v[202:203], v166 offset:2560
  v_exp_f32 v51, v51
  v_smfmac_f32_32x32x32_bf16 v[16:31], v[112:115], v[80:87], v170
  v_exp_f32 v52, v52
  ds_read_b64_tr_b16 v[204:205], v166 offset:3072
  ds_read_b64_tr_b16 v[206:207], v166 offset:3584
  v_exp_f32 v53, v53
  v_exp_f32 v54, v54
  v_exp_f32 v55, v55
  v_smfmac_f32_32x32x32_bf16 v[16:31], v[116:119], v[88:95], v170
  v_exp_f32 v56, v56
  v_exp_f32 v57, v57
  v_exp_f32 v58, v58
  ds_read_b128 v[104:107], v162 offset:12288
  v_exp_f32 v59, v59
  v_exp_f32 v60, v60
  v_exp_f32 v61, v61
  v_exp_f32 v62, v62
  v_exp_f32 v63, v63
  v_mfma_f32_32x32x16_bf16 v[80:95], v[108:111], v[100:103], 0
  v_exp_f32 v64, v64
  v_exp_f32 v65, v65
  s_waitcnt lgkmcnt(1)
  v_exp_f32 v66, v66
  s_add_u32 m0, s95, 0
  s_mov_b32 s66, 131072
  buffer_load_dwordx4 v165, s[16:19], s66 offen lds
  v_exp_f32 v67, v67
  v_smfmac_f32_32x32x32_bf16 v[32:47], v[112:115], v[48:55], v170
  v_exp_f32 v68, v68
  s_add_u32 m0, s95, 1024
  s_mov_b32 s66, 147456
  buffer_load_dwordx4 v165, s[16:19], s66 offen lds
  v_exp_f32 v69, v69
  v_exp_f32 v70, v70
  v_exp_f32 v71, v71
  v_smfmac_f32_32x32x32_bf16 v[32:47], v[116:119], v[56:63], v170
  v_exp_f32 v72, v72
  v_exp_f32 v73, v73
  v_exp_f32 v74, v74
  s_mov_b64 exec, s[84:85]
  ds_read_b128 v[112:115], v163 offset:12288
  ds_read_b128 v[116:119], v163 offset:12800
  s_mov_b64 exec, -1
  v_exp_f32 v75, v75
  v_exp_f32 v76, v76
  v_exp_f32 v77, v77
  v_exp_f32 v78, v78
  v_exp_f32 v79, v79
  s_waitcnt lgkmcnt(2)
  v_mfma_f32_32x32x16_bf16 v[48:63], v[104:107], v[96:99], 0
  s_setprio 0
  v_exp_f32 v80, v80
  v_exp_f32 v81, v81
  v_exp_f32 v82, v82
  s_add_u32 m0, s95, 2048
  s_mov_b32 s66, 163840
  buffer_load_dwordx4 v165, s[16:19], s66 offen lds
  v_exp_f32 v83, v83
  v_smfmac_f32_32x32x32_bf16 v[16:31], v[120:123], v[64:71], v170
  v_exp_f32 v84, v84
  s_add_u32 m0, s95, 3072
  s_mov_b32 s66, 180224
  buffer_load_dwordx4 v165, s[16:19], s66 offen lds
  v_exp_f32 v85, v85
  v_exp_f32 v86, v86
  v_exp_f32 v87, v87
  v_smfmac_f32_32x32x32_bf16 v[16:31], v[124:127], v[72:79], v170
  v_exp_f32 v88, v88
  v_exp_f32 v89, v89
  v_exp_f32 v90, v90
  ds_read_b128 v[108:111], v162 offset:13312
  v_exp_f32 v91, v91
  v_exp_f32 v92, v92
  v_exp_f32 v93, v93
  v_exp_f32 v94, v94
  v_exp_f32 v95, v95
  v_mfma_f32_32x32x16_bf16 v[64:79], v[104:107], v[100:103], 0
  s_cbranch_vccz L_pr_60
  s_setprio 1
L_pr_60:
  v_exp_f32 v48, v48
  v_exp_f32 v49, v49
  v_exp_f32 v50, v50
  v_exp_f32 v51, v51
  v_smfmac_f32_32x32x32_bf16 v[32:47], v[120:123], v[80:87], v170
  v_exp_f32 v52, v52
  v_exp_f32 v53, v53
  v_exp_f32 v54, v54
  v_exp_f32 v55, v55
  v_smfmac_f32_32x32x32_bf16 v[32:47], v[124:127], v[88:95], v170
  v_exp_f32 v56, v56
  v_exp_f32 v57, v57
  v_exp_f32 v58, v58
  s_mov_b64 exec, s[84:85]
  ds_read_b128 v[120:123], v163 offset:13312
  ds_read_b128 v[124:127], v163 offset:13824
  s_mov_b64 exec, -1
  v_exp_f32 v59, v59
  v_exp_f32 v60, v60
  v_exp_f32 v61, v61
  v_exp_f32 v62, v62
  v_exp_f32 v63, v63
  s_waitcnt lgkmcnt(2)
  v_mfma_f32_32x32x16_bf16 v[80:95], v[108:111], v[96:99], 0
  v_exp_f32 v64, v64
  v_exp_f32 v65, v65
  v_exp_f32 v66, v66
  v_exp_f32 v67, v67
  v_smfmac_f32_32x32x32_bf16 v[16:31], v[112:115], v[48:55], v170
  v_exp_f32 v68, v68
  v_exp_f32 v69, v69
  v_exp_f32 v70, v70
  v_exp_f32 v71, v71
  v_smfmac_f32_32x32x32_bf16 v[16:31], v[116:119], v[56:63], v170
  v_exp_f32 v72, v72
  v_exp_f32 v73, v73
  v_exp_f32 v74, v74
  ds_read_b128 v[104:107], v162 offset:14336
  v_exp_f32 v75, v75
  v_exp_f32 v76, v76
  v_exp_f32 v77, v77
  v_exp_f32 v78, v78
  v_exp_f32 v79, v79
  v_mfma_f32_32x32x16_bf16 v[48:63], v[108:111], v[100:103], 0
  v_exp_f32 v80, v80
  v_exp_f32 v81, v81
  v_exp_f32 v82, v82
  v_exp_f32 v83, v83
  v_smfmac_f32_32x32x32_bf16 v[32:47], v[112:115], v[64:71], v170
  v_exp_f32 v84, v84
  v_exp_f32 v85, v85
  v_exp_f32 v86, v86
  v_exp_f32 v87, v87
  v_smfmac_f32_32x32x32_bf16 v[32:47], v[116:119], v[72:79], v170
  v_exp_f32 v88, v88
  v_exp_f32 v89, v89
  v_exp_f32 v90, v90
  s_mov_b64 exec, s[84:85]
  ds_read_b128 v[112:115], v163 offset:14336
  ds_read_b128 v[116:119], v163 offset:14848
  s_mov_b64 exec, -1
  v_exp_f32 v91, v91
  v_exp_f32 v92, v92
  v_exp_f32 v93, v93
  v_exp_f32 v94, v94
  v_exp_f32 v95, v95
  s_waitcnt lgkmcnt(2)
  v_mfma_f32_32x32x16_bf16 v[64:79], v[104:107], v[96:99], 0
  s_setprio 0
  v_exp_f32 v48, v48
  v_exp_f32 v49, v49
  v_exp_f32 v50, v50
  v_exp_f32 v51, v51
  v_smfmac_f32_32x32x32_bf16 v[16:31], v[120:123], v[80:87], v170
  v_exp_f32 v52, v52
  v_exp_f32 v53, v53
  v_exp_f32 v54, v54
  v_exp_f32 v55, v55
  v_smfmac_f32_32x32x32_bf16 v[16:31], v[124:127], v[88:95], v170
  v_exp_f32 v56, v56
  v_exp_f32 v57, v57
  v_exp_f32 v58, v58
  ds_read_b128 v[108:111], v162 offset:15360
  v_exp_f32 v59, v59
  v_exp_f32 v60, v60
  v_exp_f32 v61, v61
  s_waitcnt vmcnt(4)
  s_mov_b64 exec, 1
  buffer_store_dword v13, v12, s[20:23], 0 offen sc1
  s_mov_b64 exec, -1
  v_exp_f32 v62, v62
  v_exp_f32 v63, v63
  v_mfma_f32_32x32x16_bf16 v[80:95], v[104:107], v[100:103], 0
  s_barrier
  s_cbranch_vccz L_pr_61
  s_setprio 1
L_pr_61:
  v_exp_f32 v64, v64
  v_exp_f32 v65, v65
  v_exp_f32 v66, v66
  v_exp_f32 v67, v67
  v_smfmac_f32_32x32x32_bf16 v[32:47], v[120:123], v[48:55], v170
  v_exp_f32 v68, v68
  v_exp_f32 v69, v69
  v_exp_f32 v70, v70
  v_exp_f32 v71, v71
  v_smfmac_f32_32x32x32_bf16 v[32:47], v[124:127], v[56:63], v170
  v_exp_f32 v72, v72
  v_exp_f32 v73, v73
  v_exp_f32 v74, v74
  s_mov_b64 exec, s[84:85]
  ds_read_b128 v[120:123], v163 offset:15360
  ds_read_b128 v[124:127], v163 offset:15872
  s_mov_b64 exec, -1
  v_exp_f32 v75, v75
  v_exp_f32 v76, v76
  v_exp_f32 v77, v77
  v_exp_f32 v78, v78
  v_exp_f32 v79, v79
  s_waitcnt lgkmcnt(2)
  v_mfma_f32_32x32x16_bf16 v[48:63], v[108:111], v[96:99], 0
  v_exp_f32 v80, v80
  v_exp_f32 v81, v81
  v_exp_f32 v82, v82
  v_exp_f32 v83, v83
  v_smfmac_f32_32x32x32_bf16 v[16:31], v[112:115], v[64:71], v170
  v_exp_f32 v84, v84
  v_exp_f32 v85, v85
  v_exp_f32 v86, v86
  v_exp_f32 v87, v87
  v_smfmac_f32_32x32x32_bf16 v[16:31], v[116:119], v[72:79], v170
  v_exp_f32 v88, v88
  v_exp_f32 v89, v89
  v_exp_f32 v90, v90
  ds_read_b128 v[104:107], v162 offset:16384
  v_exp_f32 v91, v91
  v_exp_f32 v92, v92
  v_exp_f32 v93, v93
  s_xor_b32 s66, s54, 0
  s_cmp_lt_u32 s66, 4
  s_cbranch_scc1 L_dp_73
  s_cmp_eq_u32 s92, 1
  s_cbranch_scc1 L_dp_73
  s_sub_u32 s66, s66, 4
  s_lshl_b32 s66, s66, 8
  s_lshl_b32 s67, s55, 3
  s_add_u32 s67, s67, s52
  s_mul_i32 s67, s67, 10240
  s_add_u32 s66, s66, s67
  v_lshrrev_b32 v137, 1, v1
  v_lshlrev_b32 v137, 10, v137
  v_and_b32 v138, 1, v1
  v_lshl_add_u32 v137, v138, 7, v137
  v_add_u32 v137, s66, v137
  s_mov_b64 exec, 0xfffff
  buffer_load_dword v138, v137, s[48:51], 0 offen
  s_mov_b64 exec, -1
L_dp_73:
  v_exp_f32 v94, v94
  v_exp_f32 v95, v95
  v_mfma_f32_32x32x16_bf16 v[64:79], v[108:111], v[100:103], 0
  v_exp_f32 v48, v48
  v_exp_f32 v49, v49
  v_exp_f32 v50, v50
  s_waitcnt vmcnt(1)
  ds_read_b64_tr_b16 v[208:209], v166 offset:0
  ds_read_b64_tr_b16 v[210:211], v166 offset:512
  v_exp_f32 v51, v51
  v_smfmac_f32_32x32x32_bf16 v[32:47], v[112:115], v[80:87], v170
  v_exp_f32 v52, v52
  ds_read_b64_tr_b16 v[212:213], v166 offset:1024
  ds_read_b64_tr_b16 v[214:215], v166 offset:1536
  v_exp_f32 v53, v53
  v_exp_f32 v54, v54
  s_cmp_eq_u32 s92, 0
  s_cbranch_scc1 L_mgu_74
  s_add_u32 m0, s75, 0
  s_mov_b32 s66, 0
  buffer_load_dwordx4 v167, s[48:51], s66 offen lds
L_mgu_74:
  v_exp_f32 v55, v55
  v_smfmac_f32_32x32x32_bf16 v[32:47], v[116:119], v[88:95], v170
  v_exp_f32 v56, v56
  v_exp_f32 v57, v57
  v_exp_f32 v58, v58
  s_mov_b64 exec, s[84:85]
  ds_read_b128 v[112:115], v163 offset:16384
  ds_read_b128 v[116:119], v163 offset:16896
  s_mov_b64 exec, -1
  v_exp_f32 v59, v59
  v_exp_f32 v60, v60
  v_exp_f32 v61, v61
  v_exp_f32 v62, v62
  v_exp_f32 v63, v63
  s_waitcnt lgkmcnt(6)
  v_mfma_f32_32x32x16_bf16 v[80:95], v[104:107], v[96:99], 0
  s_setprio 0
  v_exp_f32 v64, v64
  v_exp_f32 v65, v65
  v_exp_f32 v66, v66
  ds_read_b64_tr_b16 v[216:217], v166 offset:2048
  ds_read_b64_tr_b16 v[218:219], v166 offset:2560
  v_exp_f32 v67, v67
  v_smfmac_f32_32x32x32_bf16 v[16:31], v[120:123], v[48:55], v170
  v_exp_f32 v68, v68
  ds_read_b64_tr_b16 v[220:221], v166 offset:3072
  ds_read_b64_tr_b16 v[222:223], v166 offset:3584
  v_exp_f32 v69, v69
  v_exp_f32 v70, v70
  v_exp_f32 v71, v71
  v_smfmac_f32_32x32x32_bf16 v[16:31], v[124:127], v[56:63], v170
  v_exp_f32 v72, v72
  v_exp_f32 v73, v73
  v_exp_f32 v74, v74
  ds_read_b128 v[108:111], v162 offset:17408
  v_exp_f32 v75, v75
  v_exp_f32 v76, v76
  v_exp_f32 v77, v77
  v_exp_f32 v78, v78
  v_exp_f32 v79, v79
  v_mfma_f32_32x32x16_bf16 v[48:63], v[104:107], v[100:103], 0
  s_cbranch_vccz L_pr_62
  s_setprio 1
L_pr_62:
  v_exp_f32 v80, v80
  v_exp_f32 v81, v81
  s_waitcnt lgkmcnt(1)
  v_exp_f32 v82, v82
  s_add_u32 m0, s95, 0
  s_mov_b32 s66, 196608
  buffer_load_dwordx4 v165, s[16:19], s66 offen lds
  v_exp_f32 v83, v83
  v_smfmac_f32_32x32x32_bf16 v[32:47], v[120:123], v[64:71], v170
  v_exp_f32 v84, v84
  s_add_u32 m0, s95, 1024
  s_mov_b32 s66, 212992
  buffer_load_dwordx4 v165, s[16:19], s66 offen lds
  v_exp_f32 v85, v85
  v_exp_f32 v86, v86
  v_exp_f32 v87, v87
  v_smfmac_f32_32x32x32_bf16 v[32:47], v[124:127], v[72:79], v170
  v_exp_f32 v88, v88
  v_exp_f32 v89, v89
  v_exp_f32 v90, v90
  s_mov_b64 exec, s[84:85]
  ds_read_b128 v[120:123], v163 offset:17408
  ds_read_b128 v[124:127], v163 offset:17920
  s_mov_b64 exec, -1
  v_exp_f32 v91, v91
  v_exp_f32 v92, v92
  v_exp_f32 v93, v93
  v_exp_f32 v94, v94
  v_exp_f32 v95, v95
  s_waitcnt lgkmcnt(2)
  v_mfma_f32_32x32x16_bf16 v[64:79], v[108:111], v[96:99], 0
  v_exp_f32 v48, v48
  v_exp_f32 v49, v49
  v_exp_f32 v50, v50
  s_add_u32 m0, s95, 2048
  s_mov_b32 s66, 229376
  buffer_load_dwordx4 v165, s[16:19], s66 offen lds
  v_exp_f32 v51, v51
  v_smfmac_f32_32x32x32_bf16 v[16:31], v[112:115], v[80:87], v170
  v_exp_f32 v52, v52
  s_add_u32 m0, s95, 3072
  s_mov_b32 s66, 245760
  buffer_load_dwordx4 v165, s[16:19], s66 offen lds
  v_exp_f32 v53, v53
  v_exp_f32 v54, v54
  v_exp_f32 v55, v55
  v_smfmac_f32_32x32x32_bf16 v[16:31], v[116:119], v[88:95], v170
  v_exp_f32 v56, v56
  v_exp_f32 v57, v57
  v_exp_f32 v58, v58
  ds_read_b128 v[104:107], v162 offset:18432
  v_exp_f32 v59, v59
  v_exp_f32 v60, v60
  v_exp_f32 v61, v61
  v_exp_f32 v62, v62
  v_exp_f32 v63, v63
  v_mfma_f32_32x32x16_bf16 v[80:95], v[108:111], v[100:103], 0
  v_exp_f32 v64, v64
  v_exp_f32 v65, v65
  v_exp_f32 v66, v66
  v_exp_f32 v67, v67
  v_smfmac_f32_32x32x32_bf16 v[32:47], v[112:115], v[48:55], v170
  v_exp_f32 v68, v68
  v_exp_f32 v69, v69
  v_exp_f32 v70, v70
  s_cmp_eq_u32 s92, 0
  s_cbranch_scc1 L_mgu_76
  s_add_u32 m0, s75, 1024
  s_mov_b32 s66, 32768
  buffer_load_dwordx4 v167, s[48:51], s66 offen lds
  s_branch L_mj_77
L_mgu_76:
  s_add_u32 m0, s75, 0
  s_nop 0
  buffer_load_dwordx4 v167, s[40:43], 0 offen lds
L_mj_77:
  v_exp_f32 v71, v71
  v_smfmac_f32_32x32x32_bf16 v[32:47], v[116:119], v[56:63], v170
  v_exp_f32 v72, v72
  v_exp_f32 v73, v73
  v_exp_f32 v74, v74
  s_mov_b64 exec, s[84:85]
  ds_read_b128 v[112:115], v163 offset:18432
  ds_read_b128 v[116:119], v163 offset:18944
  s_mov_b64 exec, -1
  v_exp_f32 v75, v75
  v_exp_f32 v76, v76
  v_exp_f32 v77, v77
  v_exp_f32 v78, v78
  v_exp_f32 v79, v79
  s_waitcnt lgkmcnt(2)
  v_mfma_f32_32x32x16_bf16 v[48:63], v[104:107], v[96:99], 0
  s_setprio 0
  v_exp_f32 v80, v80
  v_exp_f32 v81, v81
  v_exp_f32 v82, v82
  v_exp_f32 v83, v83
  v_smfmac_f32_32x32x32_bf16 v[16:31], v[120:123], v[64:71], v170
  v_exp_f32 v84, v84
  v_exp_f32 v85, v85
  v_exp_f32 v86, v86
  v_exp_f32 v87, v87
  v_smfmac_f32_32x32x32_bf16 v[16:31], v[124:127], v[72:79], v170
  v_exp_f32 v88, v88
  v_exp_f32 v89, v89
  v_exp_f32 v90, v90
  ds_read_b128 v[108:111], v162 offset:19456
  v_exp_f32 v91, v91
  v_exp_f32 v92, v92
  v_exp_f32 v93, v93
  v_exp_f32 v94, v94
  v_exp_f32 v95, v95
  v_mfma_f32_32x32x16_bf16 v[64:79], v[104:107], v[100:103], 0
  s_cbranch_vccz L_pr_63
  s_setprio 1
L_pr_63:
  v_exp_f32 v48, v48
  v_exp_f32 v49, v49
  v_exp_f32 v50, v50
  v_exp_f32 v51, v51
  v_smfmac_f32_32x32x32_bf16 v[32:47], v[120:123], v[80:87], v170
  v_exp_f32 v52, v52
  v_exp_f32 v53, v53
  v_exp_f32 v54, v54
  v_exp_f32 v55, v55
  v_smfmac_f32_32x32x32_bf16 v[32:47], v[124:127], v[88:95], v170
  v_exp_f32 v56, v56
  v_exp_f32 v57, v57
  v_exp_f32 v58, v58
  s_mov_b64 exec, s[84:85]
  ds_read_b128 v[120:123], v163 offset:19456
  ds_read_b128 v[124:127], v163 offset:19968
  s_mov_b64 exec, -1
  v_exp_f32 v59, v59
  v_exp_f32 v60, v60
  v_exp_f32 v61, v61
  v_exp_f32 v62, v62
  v_exp_f32 v63, v63
  s_waitcnt lgkmcnt(2)
  v_mfma_f32_32x32x16_bf16 v[80:95], v[108:111], v[96:99], 0
  v_exp_f32 v64, v64
  v_exp_f32 v65, v65
  v_exp_f32 v66, v66
  v_exp_f32 v67, v67
  v_smfmac_f32_32x32x32_bf16 v[16:31], v[112:115], v[48:55], v170
  v_exp_f32 v68, v68
  v_exp_f32 v69, v69
  v_exp_f32 v70, v70
  v_exp_f32 v71, v71
  v_smfmac_f32_32x32x32_bf16 v[16:31], v[116:119], v[56:63], v170
  v_exp_f32 v72, v72
  v_exp_f32 v73, v73
  v_exp_f32 v74, v74
  ds_read_b128 v[104:107], v162 offset:20480
  v_exp_f32 v75, v75
  v_exp_f32 v76, v76
  v_exp_f32 v77, v77
  v_exp_f32 v78, v78
  v_exp_f32 v79, v79
  v_mfma_f32_32x32x16_bf16 v[48:63], v[108:111], v[100:103], 0
  v_exp_f32 v80, v80
  v_exp_f32 v81, v81
  v_exp_f32 v82, v82
  v_exp_f32 v83, v83
  v_smfmac_f32_32x32x32_bf16 v[32:47], v[112:115], v[64:71], v170
  v_exp_f32 v84, v84
  v_exp_f32 v85, v85
  v_exp_f32 v86, v86
  s_cmp_eq_u32 s92, 0
  s_cbranch_scc1 L_mgu_78
  s_add_u32 m0, s75, 2048
  s_mov_b32 s66, 65536
  buffer_load_dwordx4 v167, s[48:51], s66 offen lds
L_mgu_78:
  v_exp_f32 v87, v87
  v_smfmac_f32_32x32x32_bf16 v[32:47], v[116:119], v[72:79], v170
  v_exp_f32 v88, v88
  v_exp_f32 v89, v89
  v_exp_f32 v90, v90
  s_mov_b64 exec, s[84:85]
  ds_read_b128 v[112:115], v163 offset:20480
  ds_read_b128 v[116:119], v163 offset:20992
  s_mov_b64 exec, -1
  v_exp_f32 v91, v91
  v_exp_f32 v92, v92
  v_exp_f32 v93, v93
  v_exp_f32 v94, v94
  v_exp_f32 v95, v95
  s_waitcnt lgkmcnt(2)
  v_mfma_f32_32x32x16_bf16 v[64:79], v[104:107], v[96:99], 0
  s_setprio 0
  v_exp_f32 v48, v48
  v_exp_f32 v49, v49
  v_exp_f32 v50, v50
  v_exp_f32 v51, v51
  v_smfmac_f32_32x32x32_bf16 v[16:31], v[120:123], v[80:87], v170
  v_exp_f32 v52, v52
  v_exp_f32 v53, v53
  v_exp_f32 v54, v54
  v_exp_f32 v55, v55
  v_smfmac_f32_32x32x32_bf16 v[16:31], v[124:127], v[88:95], v170
  v_exp_f32 v56, v56
  v_exp_f32 v57, v57
  v_exp_f32 v58, v58
  ds_read_b128 v[108:111], v162 offset:21504
  v_exp_f32 v59, v59
  v_exp_f32 v60, v60
  v_exp_f32 v61, v61
  v_exp_f32 v62, v62
  v_exp_f32 v63, v63
  v_mfma_f32_32x32x16_bf16 v[80:95], v[104:107], v[100:103], 0
  s_cbranch_vccz L_pr_64
  s_setprio 1
L_pr_64:
  v_exp_f32 v64, v64
  v_exp_f32 v65, v65
  v_exp_f32 v66, v66
  s_cmp_eq_u32 s92, 0
  s_cbranch_scc1 L_vw_80
  s_waitcnt vmcnt(2)
  s_branch L_vw_81
L_vw_80:
  s_waitcnt vmcnt(1)
L_vw_81:
  ds_read_b64_tr_b16 v[224:225], v166 offset:0
  ds_read_b64_tr_b16 v[226:227], v166 offset:512
  v_exp_f32 v67, v67
  v_smfmac_f32_32x32x32_bf16 v[32:47], v[120:123], v[48:55], v170
  v_exp_f32 v68, v68
  ds_read_b64_tr_b16 v[228:229], v166 offset:1024
  ds_read_b64_tr_b16 v[230:231], v166 offset:1536
  v_exp_f32 v69, v69
  v_exp_f32 v70, v70
  v_exp_f32 v71, v71
  v_smfmac_f32_32x32x32_bf16 v[32:47], v[124:127], v[56:63], v170
  v_exp_f32 v72, v72
  v_exp_f32 v73, v73
  v_exp_f32 v74, v74
  s_mov_b64 exec, s[84:85]
  ds_read_b128 v[120:123], v163 offset:21504
  ds_read_b128 v[124:127], v163 offset:22016
  s_mov_b64 exec, -1
  v_exp_f32 v75, v75
  v_exp_f32 v76, v76
  v_exp_f32 v77, v77
  v_exp_f32 v78, v78
  v_exp_f32 v79, v79
  s_waitcnt lgkmcnt(6)
  v_mfma_f32_32x32x16_bf16 v[48:63], v[108:111], v[96:99], 0
  v_exp_f32 v80, v80
  v_exp_f32 v81, v81
  v_exp_f32 v82, v82
  ds_read_b64_tr_b16 v[232:233], v166 offset:2048
  ds_read_b64_tr_b16 v[234:235], v166 offset:2560
  v_exp_f32 v83, v83
  v_smfmac_f32_32x32x32_bf16 v[16:31], v[112:115], v[64:71], v170
  v_exp_f32 v84, v84
  ds_read_b64_tr_b16 v[236:237], v166 offset:3072
  ds_read_b64_tr_b16 v[238:239], v166 offset:3584
  v_exp_f32 v85, v85
  v_exp_f32 v86, v86
  v_exp_f32 v87, v87
  v_smfmac_f32_32x32x32_bf16 v[16:31], v[116:119], v[72:79], v170
  v_exp_f32 v88, v88
  v_exp_f32 v89, v89
  v_exp_f32 v90, v90
  ds_read_b128 v[104:107], v162 offset:22528
  v_exp_f32 v91, v91
  v_exp_f32 v92, v92
  v_exp_f32 v93, v93
  s_cmp_gt_u32 s52, 2
  s_cbranch_scc1 L_ai_83
  s_cmp_eq_u32 s52, 0
  s_cbranch_scc0 L_ai_82
  buffer_load_dword v169, v171, s[20:23], 0 offen sc1
  s_branch L_ai_83
L_ai_82:
  buffer_load_dwordx2 v[240:241], v248, s[20:23], 0 offen sc1
  buffer_load_dwordx2 v[242:243], v248, s[20:23], s86 offen sc1
  buffer_load_dwordx2 v[244:245], v248, s[20:23], s87 offen sc1
  buffer_load_dwordx2 v[246:247], v248, s[20:23], s88 offen sc1
L_ai_83:
  v_exp_f32 v94, v94
  v_exp_f32 v95, v95
  v_mfma_f32_32x32x16_bf16 v[64:79], v[108:111], v[100:103], 0
  v_exp_f32 v48, v48
  v_exp_f32 v49, v49
  v_exp_f32 v50, v50
  v_exp_f32 v51, v51
  v_smfmac_f32_32x32x32_bf16 v[32:47], v[112:115], v[80:87], v170
  v_exp_f32 v52, v52
  v_exp_f32 v53, v53
  v_exp_f32 v54, v54
  v_exp_f32 v55, v55
  v_smfmac_f32_32x32x32_bf16 v[32:47], v[116:119], v[88:95], v170
  v_exp_f32 v56, v56
  v_exp_f32 v57, v57
  v_exp_f32 v58, v58
  s_mov_b64 exec, s[84:85]
  ds_read_b128 v[112:115], v163 offset:22528
  ds_read_b128 v[116:119], v163 offset:23040
  s_mov_b64 exec, -1
  v_exp_f32 v59, v59
  v_exp_f32 v60, v60
  v_exp_f32 v61, v61
  v_exp_f32 v62, v62
  v_exp_f32 v63, v63
  s_waitcnt lgkmcnt(2)
  v_mfma_f32_32x32x16_bf16 v[80:95], v[104:107], v[96:99], 0
  s_setprio 0
  v_exp_f32 v64, v64
  v_exp_f32 v65, v65
  v_exp_f32 v66, v66
  v_exp_f32 v67, v67
  v_smfmac_f32_32x32x32_bf16 v[16:31], v[120:123], v[48:55], v170
  v_exp_f32 v68, v68
  v_exp_f32 v69, v69
  v_exp_f32 v70, v70
  v_exp_f32 v71, v71
  v_smfmac_f32_32x32x32_bf16 v[16:31], v[124:127], v[56:63], v170
  v_exp_f32 v72, v72
  v_exp_f32 v73, v73
  v_exp_f32 v74, v74
  ds_read_b128 v[108:111], v162 offset:23552
  v_exp_f32 v75, v75
  v_exp_f32 v76, v76
  v_exp_f32 v77, v77
  s_cmp_lg_u32 s52, 0
  s_cbranch_scc1 L_acd_85
L_ac_84:
  s_waitcnt vmcnt(0)
  v_cmp_eq_u32 s[66:67], s53, v169
  s_nop 0
  s_cmp_eq_u64 s[66:67], -1
  s_cbranch_scc1 L_acd_85
  buffer_load_dword v169, v171, s[20:23], 0 offen sc1
  s_cmp_eq_u32 s81, 0
  s_cbranch_scc1 L_acd_85
  s_sub_u32 s81, s81, 1
  s_branch L_ac_84
L_acd_85:
  v_exp_f32 v78, v78
  v_exp_f32 v79, v79
  v_mfma_f32_32x32x16_bf16 v[48:63], v[104:107], v[100:103], 0
  s_cbranch_vccz L_pr_65
  s_setprio 1
L_pr_65:
  v_exp_f32 v80, v80
  v_exp_f32 v81, v81
  v_exp_f32 v82, v82
  v_exp_f32 v83, v83
  v_smfmac_f32_32x32x32_bf16 v[32:47], v[120:123], v[64:71], v170
  v_exp_f32 v84, v84
  v_exp_f32 v85, v85
  v_exp_f32 v86, v86
  s_cmp_eq_u32 s92, 0
  s_cbranch_scc1 L_mgu_86
  s_add_u32 m0, s75, 3072
  s_mov_b32 s66, 98304
  buffer_load_dwordx4 v167, s[48:51], s66 offen lds
L_mgu_86:
  v_exp_f32 v87, v87
  v_smfmac_f32_32x32x32_bf16 v[32:47], v[124:127], v[72:79], v170
  v_exp_f32 v88, v88
  v_exp_f32 v89, v89
  v_exp_f32 v90, v90
  s_mov_b64 exec, s[84:85]
  ds_read_b128 v[120:123], v163 offset:23552
  ds_read_b128 v[124:127], v163 offset:24064
  s_mov_b64 exec, -1
  v_exp_f32 v91, v91
  v_exp_f32 v92, v92
  v_exp_f32 v93, v93
  v_exp_f32 v94, v94
  v_exp_f32 v95, v95
  s_waitcnt lgkmcnt(2)
  v_mfma_f32_32x32x16_bf16 v[64:79], v[108:111], v[96:99], 0
  v_exp_f32 v48, v48
  v_exp_f32 v49, v49
  v_exp_f32 v50, v50
  v_exp_f32 v51, v51
  v_smfmac_f32_32x32x32_bf16 v[16:31], v[112:115], v[80:87], v170
  v_exp_f32 v52, v52
  v_exp_f32 v53, v53
  v_exp_f32 v54, v54
  v_exp_f32 v55, v55
  v_smfmac_f32_32x32x32_bf16 v[16:31], v[116:119], v[88:95], v170
  v_exp_f32 v56, v56
  v_exp_f32 v57, v57
  v_exp_f32 v58, v58
  ds_read_b128 v[104:107], v162 offset:24576
  v_exp_f32 v59, v59
  v_exp_f32 v60, v60
  v_exp_f32 v61, v61
  v_exp_f32 v62, v62
  v_exp_f32 v63, v63
  v_mfma_f32_32x32x16_bf16 v[80:95], v[108:111], v[100:103], 0
  v_exp_f32 v64, v64
  v_exp_f32 v65, v65
  v_exp_f32 v66, v66
  v_exp_f32 v67, v67
  v_smfmac_f32_32x32x32_bf16 v[32:47], v[112:115], v[48:55], v170
  v_exp_f32 v68, v68
  v_exp_f32 v69, v69
  v_exp_f32 v70, v70
  v_exp_f32 v71, v71
  v_smfmac_f32_32x32x32_bf16 v[32:47], v[116:119], v[56:63], v170
  v_exp_f32 v72, v72
  v_exp_f32 v73, v73
  v_exp_f32 v74, v74
  s_mov_b64 exec, s[84:85]
  ds_read_b128 v[112:115], v163 offset:24576
  ds_read_b128 v[116:119], v163 offset:25088
  s_mov_b64 exec, -1
  v_exp_f32 v75, v75
  v_exp_f32 v76, v76
  v_exp_f32 v77, v77
  s_lshl_b32 s66, s52, 6
  v_add_u32 v255, s66, v1
  v_lshrrev_b32 v249, 3, v255
  v_lshlrev_b32 v249, 4, v249
  v_and_b32 v254, 7, v1
  v_add_u32 v249, v249, v254
  v_lshlrev_b32 v249, 3, v249
  v_add_u32 v249, 65536, v249
  v_lshlrev_b32 v255, 1, v255
  buffer_load_dwordx2 v[250:251], v249, s[20:23], s86 offen sc1
  buffer_load_dwordx2 v[252:253], v249, s[20:23], s87 offen sc1
  buffer_load_ushort v254, v255, s[36:39], 0 offen
  v_exp_f32 v78, v78
  v_exp_f32 v79, v79
  s_waitcnt lgkmcnt(2)
  v_mfma_f32_32x32x16_bf16 v[48:63], v[104:107], v[96:99], 0
  s_setprio 0
  v_exp_f32 v80, v80
  v_exp_f32 v81, v81
  v_exp_f32 v82, v82
  v_exp_f32 v83, v83
  v_smfmac_f32_32x32x32_bf16 v[16:31], v[120:123], v[64:71], v170
  v_exp_f32 v84, v84
  v_exp_f32 v85, v85
  v_exp_f32 v86, v86
  v_exp_f32 v87, v87
  v_smfmac_f32_32x32x32_bf16 v[16:31], v[124:127], v[72:79], v170
  v_exp_f32 v88, v88
  v_exp_f32 v89, v89
  v_exp_f32 v90, v90
  ds_read_b128 v[108:111], v162 offset:25600
  v_exp_f32 v91, v91
  v_exp_f32 v92, v92
  v_exp_f32 v93, v93
  v_exp_f32 v94, v94
  v_exp_f32 v95, v95
  v_mfma_f32_32x32x16_bf16 v[64:79], v[104:107], v[100:103], 0
  s_cbranch_vccz L_pr_66
  s_setprio 1
L_pr_66:
  v_exp_f32 v48, v48
  v_exp_f32 v49, v49
  v_exp_f32 v50, v50
  v_exp_f32 v51, v51
  v_smfmac_f32_32x32x32_bf16 v[32:47], v[120:123], v[80:87], v170
  v_exp_f32 v52, v52
  v_exp_f32 v53, v53
  v_exp_f32 v54, v54
  s_cmp_eq_u32 s92, 0
  s_cbranch_scc1 L_mgu_88
  s_add_u32 m0, s75, 4096
  s_mov_b32 s66, 131072
  buffer_load_dwordx4 v167, s[48:51], s66 offen lds
  s_branch L_mj_89
L_mgu_88:
  s_add_u32 m0, s75, 1024
  s_nop 0
  buffer_load_dwordx4 v167, s[44:47], 0 offen lds
L_mj_89:
  v_exp_f32 v55, v55
  v_smfmac_f32_32x32x32_bf16 v[32:47], v[124:127], v[88:95], v170
  v_exp_f32 v56, v56
  v_exp_f32 v57, v57
  v_exp_f32 v58, v58
  s_mov_b64 exec, s[84:85]
  ds_read_b128 v[120:123], v163 offset:25600
  ds_read_b128 v[124:127], v163 offset:26112
  s_mov_b64 exec, -1
  v_exp_f32 v59, v59
  v_exp_f32 v60, v60
  v_exp_f32 v61, v61
  v_exp_f32 v62, v62
  v_exp_f32 v63, v63
  s_waitcnt lgkmcnt(2)
  v_mfma_f32_32x32x16_bf16 v[80:95], v[108:111], v[96:99], 0
  v_exp_f32 v64, v64
  v_exp_f32 v65, v65
  v_exp_f32 v66, v66
  v_exp_f32 v67, v67
  v_smfmac_f32_32x32x32_bf16 v[16:31], v[112:115], v[48:55], v170
  v_exp_f32 v68, v68
  v_exp_f32 v69, v69
  v_exp_f32 v70, v70
  v_exp_f32 v71, v71
  v_smfmac_f32_32x32x32_bf16 v[16:31], v[116:119], v[56:63], v170
  v_exp_f32 v72, v72
  v_exp_f32 v73, v73
  v_exp_f32 v74, v74
  ds_read_b128 v[104:107], v162 offset:26624
  v_exp_f32 v75, v75
  v_exp_f32 v76, v76
  v_exp_f32 v77, v77
  s_cmp_lg_u32 s52, 1
  s_cbranch_scc1 L_wm_91
  s_and_b32 s66, s60, 3
  s_lshl_b32 s66, s66, 11
  s_lshr_b32 s67, s60, 2
  s_and_b32 s67, s67, 7
  s_lshl_b32 s67, s67, 14
  s_add_u32 s66, s66, s67
  s_lshr_b32 s67, s60, 5
  s_lshl_b32 s67, s67, 13
  s_xor_b32 s67, s67, s0
  s_add_u32 s66, s66, s67
  s_add_u32 s66, s66, 262144
  v_lshl_add_u32 v136, v1, 4, s66
  buffer_load_dwordx4 v[128:131], v136, s[20:23], 0 offen sc1
  buffer_load_dwordx4 v[132:135], v136, s[20:23], 0 offen offset:1024 sc1
  s_branch L_wme_90
L_wm_91:
  s_cmp_lg_u32 s52, 2
  s_cbranch_scc1 L_wm_92
  s_mov_b32 s66, s60
  s_lshl_b32 s66, s66, 12
  s_add_u32 s66, s66, 524288
  s_lshl_b32 s67, s61, 10
  s_add_u32 s66, s66, s67
  v_lshl_add_u32 v136, v1, 4, s66
  buffer_load_dwordx4 v[128:131], v136, s[20:23], 0 offen sc1
  s_branch L_wme_90
L_wm_92:
  s_cmp_lg_u32 s52, 3
  s_cbranch_scc1 L_wm_93
  s_and_b32 s66, s54, 3
  s_lshl_b32 s66, s66, 14
  s_lshr_b32 s67, s54, 2
  s_lshl_b32 s67, s67, 13
  s_xor_b32 s67, s67, s0
  s_add_u32 s66, s66, s67
  s_add_u32 s66, s66, 786432
  v_lshl_add_u32 v136, v1, 7, s66
  buffer_load_dwordx2 v[128:129], v136, s[20:23], 0 offen sc1
  s_branch L_wme_90
L_wm_93:
  s_cmp_lg_u32 s52, 4
  s_cbranch_scc1 L_wm_94
  s_lshl_b32 s66, s93, 5
  s_xor_b32 s67, s0, 8192
  s_add_u32 s66, s66, s67
  s_add_u32 s66, s66, 131072
  v_and_b32 v136, 7, v1
  v_lshl_add_u32 v136, v136, 3, s66
  v_bfe_u32 v137, v1, 3, 0
  v_lshl_add_u32 v136, v137, 14, v136
  buffer_load_dwordx2 v[128:129], v136, s[20:23], 0 offen sc1
  s_branch L_wme_90
L_wm_94:
L_wme_90:
  v_exp_f32 v78, v78
  v_exp_f32 v79, v79
  v_mfma_f32_32x32x16_bf16 v[48:63], v[108:111], v[100:103], 0
  v_exp_f32 v80, v80
  v_exp_f32 v81, v81
  v_exp_f32 v82, v82
  v_exp_f32 v83, v83
  v_smfmac_f32_32x32x32_bf16 v[32:47], v[112:115], v[64:71], v170
  v_exp_f32 v84, v84
  v_exp_f32 v85, v85
  v_exp_f32 v86, v86
  v_exp_f32 v87, v87
  v_smfmac_f32_32x32x32_bf16 v[32:47], v[116:119], v[72:79], v170
  v_exp_f32 v88, v88
  v_exp_f32 v89, v89
  v_exp_f32 v90, v90
  s_mov_b64 exec, s[84:85]
  ds_read_b128 v[112:115], v163 offset:26624
  ds_read_b128 v[116:119], v163 offset:27136
  s_mov_b64 exec, -1
  v_exp_f32 v91, v91
  v_exp_f32 v92, v92
  v_exp_f32 v93, v93
  v_exp_f32 v94, v94
  v_exp_f32 v95, v95
  s_waitcnt lgkmcnt(2)
  v_mfma_f32_32x32x16_bf16 v[64:79], v[104:107], v[96:99], 0
  s_setprio 0
  v_exp_f32 v48, v48
  v_exp_f32 v49, v49
  v_exp_f32 v50, v50
  v_exp_f32 v51, v51
  v_smfmac_f32_32x32x32_bf16 v[16:31], v[120:123], v[80:87], v170
  v_exp_f32 v52, v52
  v_exp_f32 v53, v53
  v_exp_f32 v54, v54
  v_exp_f32 v55, v55
  v_smfmac_f32_32x32x32_bf16 v[16:31], v[124:127], v[88:95], v170
  v_exp_f32 v56, v56
  v_exp_f32 v57, v57
  v_exp_f32 v58, v58
  ds_read_b128 v[108:111], v162 offset:27648
  v_exp_f32 v59, v59
  v_exp_f32 v60, v60
  v_exp_f32 v61, v61
  v_exp_f32 v62, v62
  v_exp_f32 v63, v63
  v_mfma_f32_32x32x16_bf16 v[80:95], v[104:107], v[100:103], 0
  s_cbranch_vccz L_pr_67
  s_setprio 1
L_pr_67:
  v_exp_f32 v64, v64
  v_exp_f32 v65, v65
  v_exp_f32 v66, v66
  v_exp_f32 v67, v67
  v_smfmac_f32_32x32x32_bf16 v[32:47], v[120:123], v[48:55], v170
  v_exp_f32 v68, v68
  v_exp_f32 v69, v69
  v_exp_f32 v70, v70
  s_cmp_eq_u32 s92, 0
  s_cbranch_scc1 L_mgu_95
  s_add_u32 m0, s75, 5120
  s_mov_b32 s66, 163840
  buffer_load_dwordx4 v167, s[48:51], s66 offen lds
L_mgu_95:
  v_exp_f32 v71, v71
  v_smfmac_f32_32x32x32_bf16 v[32:47], v[124:127], v[56:63], v170
  v_exp_f32 v72, v72
  v_exp_f32 v73, v73
  v_exp_f32 v74, v74
  s_mov_b64 exec, s[84:85]
  ds_read_b128 v[120:123], v163 offset:27648
  ds_read_b128 v[124:127], v163 offset:28160
  s_mov_b64 exec, -1
  v_exp_f32 v75, v75
  v_exp_f32 v76, v76
  v_exp_f32 v77, v77
  v_exp_f32 v78, v78
  v_exp_f32 v79, v79
  s_waitcnt lgkmcnt(2)
  v_mfma_f32_32x32x16_bf16 v[48:63], v[108:111], v[96:99], 0
  v_exp_f32 v80, v80
  v_exp_f32 v81, v81
  v_exp_f32 v82, v82
  v_exp_f32 v83, v83
  v_smfmac_f32_32x32x32_bf16 v[16:31], v[112:115], v[64:71], v170
  v_exp_f32 v84, v84
  v_exp_f32 v85, v85
  v_exp_f32 v86, v86
  v_exp_f32 v87, v87
  v_smfmac_f32_32x32x32_bf16 v[16:31], v[116:119], v[72:79], v170
  v_exp_f32 v88, v88
  v_exp_f32 v89, v89
  v_exp_f32 v90, v90
  ds_read_b128 v[104:107], v162 offset:28672
  v_exp_f32 v91, v91
  v_exp_f32 v92, v92
  v_exp_f32 v93, v93
  v_exp_f32 v94, v94
  v_exp_f32 v95, v95
  v_mfma_f32_32x32x16_bf16 v[64:79], v[108:111], v[100:103], 0
  v_exp_f32 v48, v48
  v_exp_f32 v49, v49
  v_exp_f32 v50, v50
  v_exp_f32 v51, v51
  v_smfmac_f32_32x32x32_bf16 v[32:47], v[112:115], v[80:87], v170
  v_exp_f32 v52, v52
  v_exp_f32 v53, v53
  v_exp_f32 v54, v54
  v_exp_f32 v55, v55
  v_smfmac_f32_32x32x32_bf16 v[32:47], v[116:119], v[88:95], v170
  v_exp_f32 v56, v56
  v_exp_f32 v57, v57
  v_exp_f32 v58, v58
  s_mov_b64 exec, s[84:85]
  ds_read_b128 v[112:115], v163 offset:28672
  ds_read_b128 v[116:119], v163 offset:29184
  s_mov_b64 exec, -1
  v_exp_f32 v59, v59
  v_exp_f32 v60, v60
  v_exp_f32 v61, v61
  v_exp_f32 v62, v62
  v_exp_f32 v63, v63
  s_waitcnt lgkmcnt(2)
  v_mfma_f32_32x32x16_bf16 v[80:95], v[104:107], v[96:99], 0
  s_setprio 0
  v_exp_f32 v64, v64
  v_exp_f32 v65, v65
  v_exp_f32 v66, v66
  v_exp_f32 v67, v67
  v_smfmac_f32_32x32x32_bf16 v[16:31], v[120:123], v[48:55], v170
  v_exp_f32 v68, v68
  v_exp_f32 v69, v69
  v_exp_f32 v70, v70
  v_exp_f32 v71, v71
  v_smfmac_f32_32x32x32_bf16 v[16:31], v[124:127], v[56:63], v170
  v_exp_f32 v72, v72
  v_exp_f32 v73, v73
  v_exp_f32 v74, v74
  ds_read_b128 v[108:111], v162 offset:29696
  v_exp_f32 v75, v75
  v_exp_f32 v76, v76
  v_exp_f32 v77, v77
  v_exp_f32 v78, v78
  v_exp_f32 v79, v79
  v_mfma_f32_32x32x16_bf16 v[48:63], v[104:107], v[100:103], 0
  s_cbranch_vccz L_pr_68
  s_setprio 1
L_pr_68:
  v_exp_f32 v80, v80
  v_exp_f32 v81, v81
  v_exp_f32 v82, v82
  v_exp_f32 v83, v83
  v_smfmac_f32_32x32x32_bf16 v[32:47], v[120:123], v[64:71], v170
  v_exp_f32 v84, v84
  v_exp_f32 v85, v85
  v_exp_f32 v86, v86
  s_cmp_eq_u32 s92, 0
  s_cbranch_scc1 L_mgu_97
  s_add_u32 m0, s75, 6144
  s_mov_b32 s66, 196608
  buffer_load_dwordx4 v167, s[48:51], s66 offen lds
L_mgu_97:
  v_exp_f32 v87, v87
  v_smfmac_f32_32x32x32_bf16 v[32:47], v[124:127], v[72:79], v170
  v_exp_f32 v88, v88
  v_exp_f32 v89, v89
  v_exp_f32 v90, v90
  s_mov_b64 exec, s[84:85]
  ds_read_b128 v[120:123], v163 offset:29696
  ds_read_b128 v[124:127], v163 offset:30208
  s_mov_b64 exec, -1
  v_exp_f32 v91, v91
  v_exp_f32 v92, v92
  v_exp_f32 v93, v93
  v_exp_f32 v94, v94
  v_exp_f32 v95, v95
  s_waitcnt lgkmcnt(2)
  v_mfma_f32_32x32x16_bf16 v[64:79], v[108:111], v[96:99], 0
  v_exp_f32 v48, v48
  v_exp_f32 v49, v49
  v_exp_f32 v50, v50
  v_exp_f32 v51, v51
  v_smfmac_f32_32x32x32_bf16 v[16:31], v[112:115], v[80:87], v170
  v_exp_f32 v52, v52
  v_exp_f32 v53, v53
  v_exp_f32 v54, v54
  v_exp_f32 v55, v55
  v_smfmac_f32_32x32x32_bf16 v[16:31], v[116:119], v[88:95], v170
  v_exp_f32 v56, v56
  v_exp_f32 v57, v57
  v_exp_f32 v58, v58
  ds_read_b128 v[104:107], v162 offset:30720
  v_exp_f32 v59, v59
  v_exp_f32 v60, v60
  v_exp_f32 v61, v61
  v_exp_f32 v62, v62
  v_exp_f32 v63, v63
  v_mfma_f32_32x32x16_bf16 v[80:95], v[108:111], v[100:103], 0
  v_exp_f32 v64, v64
  v_exp_f32 v65, v65
  v_exp_f32 v66, v66
  v_exp_f32 v67, v67
  v_smfmac_f32_32x32x32_bf16 v[32:47], v[112:115], v[48:55], v170
  v_exp_f32 v68, v68
  v_exp_f32 v69, v69
  v_exp_f32 v70, v70
  v_exp_f32 v71, v71
  v_smfmac_f32_32x32x32_bf16 v[32:47], v[116:119], v[56:63], v170
  v_exp_f32 v72, v72
  v_exp_f32 v73, v73
  v_exp_f32 v74, v74
  s_mov_b64 exec, s[84:85]
  ds_read_b128 v[112:115], v163 offset:30720
  ds_read_b128 v[116:119], v163 offset:31232
  s_mov_b64 exec, -1
  v_exp_f32 v75, v75
  v_exp_f32 v76, v76
  v_exp_f32 v77, v77
  v_exp_f32 v78, v78
  v_exp_f32 v79, v79
  s_waitcnt lgkmcnt(2)
  v_mfma_f32_32x32x16_bf16 v[48:63], v[104:107], v[96:99], 0
  s_setprio 0
  v_exp_f32 v80, v80
  v_exp_f32 v81, v81
  v_exp_f32 v82, v82
  v_exp_f32 v83, v83
  v_smfmac_f32_32x32x32_bf16 v[16:31], v[120:123], v[64:71], v170
  v_exp_f32 v84, v84
  v_exp_f32 v85, v85
  v_exp_f32 v86, v86
  v_exp_f32 v87, v87
  v_smfmac_f32_32x32x32_bf16 v[16:31], v[124:127], v[72:79], v170
  v_exp_f32 v88, v88
  v_exp_f32 v89, v89
  v_exp_f32 v90, v90
  ds_read_b128 v[108:111], v162 offset:31744
  v_exp_f32 v91, v91
  v_exp_f32 v92, v92
  v_exp_f32 v93, v93
  v_exp_f32 v94, v94
  v_exp_f32 v95, v95
  v_mfma_f32_32x32x16_bf16 v[64:79], v[104:107], v[100:103], 0
  s_cbranch_vccz L_pr_69
  s_setprio 1
L_pr_69:
  v_exp_f32 v48, v48
  v_exp_f32 v49, v49
  v_exp_f32 v50, v50
  v_exp_f32 v51, v51
  v_smfmac_f32_32x32x32_bf16 v[32:47], v[120:123], v[80:87], v170
  v_exp_f32 v52, v52
  v_exp_f32 v53, v53
  v_exp_f32 v54, v54
  v_exp_f32 v55, v55
  v_smfmac_f32_32x32x32_bf16 v[32:47], v[124:127], v[88:95], v170
  v_exp_f32 v56, v56
  v_exp_f32 v57, v57
  v_exp_f32 v58, v58
  s_mov_b64 exec, s[84:85]
  ds_read_b128 v[120:123], v163 offset:31744
  ds_read_b128 v[124:127], v163 offset:32256
  s_mov_b64 exec, -1
  v_exp_f32 v59, v59
  v_exp_f32 v60, v60
  v_exp_f32 v61, v61
  v_exp_f32 v62, v62
  v_exp_f32 v63, v63
  s_waitcnt lgkmcnt(2)
  v_mfma_f32_32x32x16_bf16 v[80:95], v[108:111], v[96:99], 0
  v_exp_f32 v64, v64
  v_exp_f32 v65, v65
  v_exp_f32 v66, v66
  v_exp_f32 v67, v67
  v_smfmac_f32_32x32x32_bf16 v[16:31], v[112:115], v[48:55], v170
  v_exp_f32 v68, v68
  v_exp_f32 v69, v69
  v_exp_f32 v70, v70
  v_exp_f32 v71, v71
  v_smfmac_f32_32x32x32_bf16 v[16:31], v[116:119], v[56:63], v170
  v_exp_f32 v72, v72
  v_exp_f32 v73, v73
  v_exp_f32 v74, v74
  v_exp_f32 v75, v75
  v_exp_f32 v76, v76
  v_exp_f32 v77, v77
  v_exp_f32 v78, v78
  v_exp_f32 v79, v79
  v_mfma_f32_32x32x16_bf16 v[48:63], v[108:111], v[100:103], 0
  v_exp_f32 v80, v80
  v_exp_f32 v81, v81
  v_exp_f32 v82, v82
  v_exp_f32 v83, v83
  v_smfmac_f32_32x32x32_bf16 v[32:47], v[112:115], v[64:71], v170
  v_exp_f32 v84, v84
  v_exp_f32 v85, v85
  v_exp_f32 v86, v86
  v_exp_f32 v87, v87
  v_smfmac_f32_32x32x32_bf16 v[32:47], v[116:119], v[72:79], v170
  v_exp_f32 v88, v88
  v_exp_f32 v89, v89
  v_exp_f32 v90, v90
  v_exp_f32 v91, v91
  v_exp_f32 v92, v92
  v_exp_f32 v93, v93
  v_exp_f32 v94, v94
  v_exp_f32 v95, v95
  s_setprio 0
  v_exp_f32 v48, v48
  v_exp_f32 v49, v49
  v_exp_f32 v50, v50
  v_exp_f32 v51, v51
  s_waitcnt lgkmcnt(0)
  v_smfmac_f32_32x32x32_bf16 v[16:31], v[120:123], v[80:87], v170
  v_exp_f32 v52, v52
  v_exp_f32 v53, v53
  v_exp_f32 v54, v54
  v_exp_f32 v55, v55
  v_smfmac_f32_32x32x32_bf16 v[16:31], v[124:127], v[88:95], v170
  v_exp_f32 v56, v56
  v_exp_f32 v57, v57
  v_exp_f32 v58, v58
  v_exp_f32 v59, v59
  v_exp_f32 v60, v60
  v_exp_f32 v61, v61
  v_exp_f32 v62, v62
  v_exp_f32 v63, v63
  s_nop 1
  v_smfmac_f32_32x32x32_bf16 v[32:47], v[120:123], v[48:55], v170
  v_smfmac_f32_32x32x32_bf16 v[32:47], v[124:127], v[56:63], v170
  s_setprio 0
  s_nop 10
  ds_write_b128 v5, v[32:35]
  ds_write_b128 v5, v[36:39] offset:1024
  ds_write_b32 v6, v40 offset:2048
  s_waitcnt lgkmcnt(0)
  s_barrier
  ds_read_b32 v56, v8 offset:2048
  ds_read_b128 v[48:51], v7
  ds_read_b128 v[52:55], v7 offset:1024
  s_waitcnt lgkmcnt(2)
  v_add_f32 v24, v24, v56
  v_rcp_f32 v14, v24
  v_cmp_le_f32 vcc, 0x21800000, v24
  v_cmp_le_f32 s[66:67], v24, v10
  s_waitcnt lgkmcnt(0)
  v_add_f32 v16, v16, v48
  v_add_f32 v17, v17, v49
  v_add_f32 v18, v18, v50
  v_add_f32 v19, v19, v51
  v_add_f32 v20, v20, v52
  v_add_f32 v21, v21, v53
  v_add_f32 v22, v22, v54
  v_add_f32 v23, v23, v55
  s_and_b64 vcc, vcc, s[66:67]
  v_add_f32 v48, |v16|, |v17|
  v_add_f32 v49, |v18|, |v19|
  v_add_f32 v50, |v20|, |v21|
  v_add_f32 v51, |v22|, |v23|
  v_add_f32 v48, v48, v49
  v_add_f32 v50, v50, v51
  v_add_f32 v48, v48, v50
  v_cmp_lt_f32 s[66:67], v48, v11
  s_nop 0
  s_and_b64 vcc, vcc, s[66:67]
  s_cmp_eq_u64 vcc, exec
  s_cbranch_scc1 L_att_ok_99
  v_lshlrev_b32 v162, 4, v1
  v_and_b32 v163, 15, v1
  v_lshlrev_b32 v163, 4, v163
  v_lshrrev_b32 v6, 5, v1
  v_lshl_add_u32 v163, v6, 8, v163
  v_add_u32 v163, 65536, v163
  v_mov_b32 v64, 0xff800000
  s_lshl_b32 s68, s58, 16
  s_add_u32 s69, s68, 3145728
  v_add_u32 v162, s69, v162
  s_add_u32 s69, s68, 5177344
  v_add_u32 v163, s69, v163
  v_mov_b32 v16, 0
  v_mov_b32 v17, 0
  v_mov_b32 v18, 0
  v_mov_b32 v19, 0
  v_mov_b32 v20, 0
  v_mov_b32 v21, 0
  v_mov_b32 v22, 0
  v_mov_b32 v23, 0
  v_mov_b32 v24, 0
  v_mov_b32 v25, 0
  v_mov_b32 v26, 0
  v_mov_b32 v27, 0
  v_mov_b32 v28, 0
  v_mov_b32 v29, 0
  v_mov_b32 v30, 0
  v_mov_b32 v31, 0
  s_mov_b32 s74, 0
L_fb_100:
  buffer_load_dwordx4 v[104:107], v162, s[20:23], 0 offen offset:0 sc1
  s_mov_b64 exec, s[84:85]
  buffer_load_dwordx4 v[112:115], v163, s[20:23], 0 offen offset:0 sc1
  buffer_load_dwordx4 v[116:119], v163, s[20:23], 0 offen offset:512 sc1
  s_mov_b64 exec, -1
  s_waitcnt vmcnt(0) lgkmcnt(0)
  v_mfma_f32_32x32x16_bf16 v[48:63], v[104:107], v[96:99], 0
  s_nop 7
  s_nop 3
  v_max_f32 v65, v48, v49
  v_max3_f32 v65, v65, v50, v51
  v_max3_f32 v65, v65, v52, v53
  v_max3_f32 v65, v65, v54, v55
  v_max3_f32 v65, v65, v56, v57
  v_max3_f32 v65, v65, v58, v59
  v_max3_f32 v65, v65, v60, v61
  v_max3_f32 v65, v65, v62, v63
  v_mov_b32 v66, v65
  s_nop 1
  v_permlane32_swap_b32 v65, v66
  v_max3_f32 v65, v65, v66, v64
  v_sub_f32 v66, v64, v65
  v_exp_f32 v66, v66
  v_mov_b32 v64, v65
  v_sub_f32 v48, v48, v64
  v_exp_f32 v48, v48
  v_mul_f32 v16, v16, v66
  v_sub_f32 v49, v49, v64
  v_exp_f32 v49, v49
  v_mul_f32 v17, v17, v66
  v_sub_f32 v50, v50, v64
  v_exp_f32 v50, v50
  v_mul_f32 v18, v18, v66
  v_sub_f32 v51, v51, v64
  v_exp_f32 v51, v51
  v_mul_f32 v19, v19, v66
  v_sub_f32 v52, v52, v64
  v_exp_f32 v52, v52
  v_mul_f32 v20, v20, v66
  v_sub_f32 v53, v53, v64
  v_exp_f32 v53, v53
  v_mul_f32 v21, v21, v66
  v_sub_f32 v54, v54, v64
  v_exp_f32 v54, v54
  v_mul_f32 v22, v22, v66
  v_sub_f32 v55, v55, v64
  v_exp_f32 v55, v55
  v_mul_f32 v23, v23, v66
  v_sub_f32 v56, v56, v64
  v_exp_f32 v56, v56
  v_mul_f32 v24, v24, v66
  v_sub_f32 v57, v57, v64
  v_exp_f32 v57, v57
  v_mul_f32 v25, v25, v66
  v_sub_f32 v58, v58, v64
  v_exp_f32 v58, v58
  v_mul_f32 v26, v26, v66
  v_sub_f32 v59, v59, v64
  v_exp_f32 v59, v59
  v_mul_f32 v27, v27, v66
  v_sub_f32 v60, v60, v64
  v_exp_f32 v60, v60
  v_mul_f32 v28, v28, v66
  v_sub_f32 v61, v61, v64
  v_exp_f32 v61, v61
  v_mul_f32 v29, v29, v66
  v_sub_f32 v62, v62, v64
  v_exp_f32 v62, v62
  v_mul_f32 v30, v30, v66
  v_sub_f32 v63, v63, v64
  v_exp_f32 v63, v63
  v_mul_f32 v31, v31, v66
  v_cvt_pk_bf16_f32 v80, v48, v49
  v_cvt_pk_bf16_f32 v81, v50, v51
  v_cvt_pk_bf16_f32 v82, v52, v53
  v_cvt_pk_bf16_f32 v83, v54, v55
  v_cvt_pk_bf16_f32 v84, v56, v57
  v_cvt_pk_bf16_f32 v85, v58, v59
  v_cvt_pk_bf16_f32 v86, v60, v61
  v_cvt_pk_bf16_f32 v87, v62, v63
  s_nop 1
  v_mfma_f32_32x32x16_bf16 v[16:31], v[112:115], v[80:83], v[16:31]
  v_mfma_f32_32x32x16_bf16 v[16:31], v[116:119], v[84:87], v[16:31]
  v_add_u32 v162, 1024, v162
  v_add_u32 v163, 1024, v163
  s_add_u32 s74, s74, 1
  s_cmp_lt_u32 s74, 64
  s_nop 7
  s_cbranch_scc1 L_fb_100
  s_nop 7
  v_rcp_f32 v14, v24
  s_nop 0
L_att_ok_99:
  v_mul_f32 v16, v16, v14
  v_mul_f32 v17, v17, v14
  v_mul_f32 v18, v18, v14
  v_mul_f32 v19, v19, v14
  v_mul_f32 v20, v20, v14
  v_mul_f32 v21, v21, v14
  v_mul_f32 v22, v22, v14
  v_mul_f32 v23, v23, v14
  v_cvt_pk_bf16_f32 v80, v16, v17
  v_cvt_pk_bf16_f32 v81, v18, v19
  v_cvt_pk_bf16_f32 v82, v20, v21
  v_cvt_pk_bf16_f32 v83, v22, v23
  buffer_store_dwordx4 v[80:83], v9, s[20:23], s76 offen sc1
  s_and_b32 s68, s60, 31
  s_lshl_b32 s68, s68, 16
  s_lshr_b32 s67, s60, 5
  s_lshl_b32 s67, s67, 13
  s_xor_b32 s67, s67, s1
  s_add_u32 s68, s68, s67
  s_add_u32 s68, s68, 8388608
  s_lshr_b32 s67, s52, 1
  s_lshl_b32 s67, s67, 14
  s_add_u32 s68, s68, s67
  s_and_b32 s67, s52, 1
  s_lshl_b32 s67, s67, 12
  s_add_u32 s68, s68, s67
  s_lshl_b32 s69, s64, 12
  s_lshl_b32 s67, s63, 15
  s_add_u32 s69, s69, s67
  s_add_u32 s69, s69, 16384
  v_lshlrev_b32 v9, 4, v1
  v_add_u32 v8, s69, v9
  s_add_u32 m0, s69, 0
  s_add_u32 s66, s68, 0
  buffer_load_dwordx4 v9, s[20:23], s66 offen sc1 lds
  s_add_u32 m0, s69, 1024
  s_add_u32 s66, s68, 1024
  buffer_load_dwordx4 v9, s[20:23], s66 offen sc1 lds
  s_add_u32 m0, s69, 2048
  s_add_u32 s66, s68, 2048
  buffer_load_dwordx4 v9, s[20:23], s66 offen sc1 lds
  s_add_u32 m0, s69, 3072
  s_add_u32 s66, s68, 3072
  buffer_load_dwordx4 v9, s[20:23], s66 offen sc1 lds
  s_waitcnt vmcnt(5)
  s_cmp_eq_u32 s92, 0
  s_cbranch_scc1 L_rgu_103
  ds_read_b64_tr_b16 v[128:129], v168 offset:0
  ds_read_b64_tr_b16 v[130:131], v168 offset:512
  ds_read_b64_tr_b16 v[132:133], v168 offset:1024
  ds_read_b64_tr_b16 v[134:135], v168 offset:1536
  ds_read_b64_tr_b16 v[136:137], v168 offset:2048
  ds_read_b64_tr_b16 v[138:139], v168 offset:2560
  ds_read_b64_tr_b16 v[140:141], v168 offset:3072
  ds_read_b64_tr_b16 v[142:143], v168 offset:3584
  ds_read_b64_tr_b16 v[144:145], v168 offset:4096
  ds_read_b64_tr_b16 v[146:147], v168 offset:4608
  ds_read_b64_tr_b16 v[148:149], v168 offset:5120
  ds_read_b64_tr_b16 v[150:151], v168 offset:5632
  ds_read_b64_tr_b16 v[152:153], v168 offset:6144
  ds_read_b64_tr_b16 v[154:155], v168 offset:6656
  s_branch L_rj_104
L_rgu_103:
  ds_read_b64_tr_b16 v[128:129], v168 offset:0
  ds_read_b64_tr_b16 v[130:131], v168 offset:256
  ds_read_b64_tr_b16 v[132:133], v168 offset:512
  ds_read_b64_tr_b16 v[134:135], v168 offset:768
L_rj_104:
  s_mov_b32 s94, 0
  s_mov_b32 s3, 0
  s_sub_u32 s66, s52, 1
  s_cmp_ge_u32 s66, 2
  s_cbranch_scc1 L_vecd_105
  s_lshl_b32 s66, s66, 6
  v_add_u32 v6, s66, v1
  v_mov_b32 v20, v240
  v_mov_b32 v21, v241
  v_mov_b32 v22, v242
  v_mov_b32 v23, v243
  v_mov_b32 v24, v244
  v_mov_b32 v25, v245
  v_mov_b32 v26, v246
  v_mov_b32 v27, v247
  v_mov_b32 v7, v248
L_vp_106:
  v_cmp_eq_u32 vcc, s53, v21
  v_cmp_eq_u32 s[72:73], s53, v23
  s_nop 0
  s_and_b64 vcc, vcc, s[72:73]
  v_cmp_eq_u32 s[72:73], s53, v25
  s_nop 0
  s_and_b64 vcc, vcc, s[72:73]
  v_cmp_eq_u32 s[72:73], s53, v27
  s_nop 0
  s_and_b64 vcc, vcc, s[72:73]
  s_cmp_eq_u64 vcc, exec
  s_cbranch_scc1 L_vpd_107
  buffer_load_dwordx2 v[20:21], v7, s[20:23], 0 offen sc1
  buffer_load_dwordx2 v[22:23], v7, s[20:23], s86 offen sc1
  buffer_load_dwordx2 v[24:25], v7, s[20:23], s87 offen sc1
  buffer_load_dwordx2 v[26:27], v7, s[20:23], s88 offen sc1
  s_waitcnt vmcnt(0)
  s_cmp_eq_u32 s81, 0
  s_cbranch_scc1 L_vpd_107
  s_sub_u32 s81, s81, 1
  s_branch L_vp_106
L_vpd_107:
  v_lshlrev_b32 v30, 16, v160
  v_mul_f32 v28, v24, v30
L_vecd_105:
L_ub_108:
  v_cmp_eq_u32 vcc, s53, v251
  v_cmp_eq_u32 s[72:73], s53, v253
  s_nop 0
  s_and_b64 vcc, vcc, s[72:73]
  s_cmp_eq_u64 vcc, exec
  s_cbranch_scc1 L_ubd_109
  buffer_load_dwordx2 v[250:251], v249, s[20:23], s86 offen sc1
  buffer_load_dwordx2 v[252:253], v249, s[20:23], s87 offen sc1
  s_waitcnt vmcnt(0)
  s_cmp_eq_u32 s81, 0
  s_cbranch_scc1 L_ubd_109
  s_sub_u32 s81, s81, 1
  s_branch L_ub_108
L_ubd_109:
  v_lshlrev_b32 v254, 16, v254
  v_mul_f32 v252, v252, v254
  v_mul_f32 v253, v250, v254
  s_lshl_b32 s66, s52, 3
  s_add_u32 s66, s66, 146432
  v_mov_b32 v249, s66
  v_add_f32_dpp v252, v252, v252 row_shr:1 row_mask:0xf bank_mask:0xf bound_ctrl:0
  s_nop 1
  v_add_f32_dpp v252, v252, v252 row_shr:2 row_mask:0xf bank_mask:0xf bound_ctrl:0
  s_nop 1
  v_add_f32_dpp v252, v252, v252 row_shr:4 row_mask:0xf bank_mask:0xf bound_ctrl:0
  s_nop 1
  v_add_f32_dpp v252, v252, v252 row_shr:8 row_mask:0xf bank_mask:0xf bound_ctrl:0
  s_nop 1
  v_add_f32_dpp v252, v252, v252 row_bcast:15 row_mask:0xa bank_mask:0xf
  s_nop 1
  v_add_f32_dpp v252, v252, v252 row_bcast:31 row_mask:0xc bank_mask:0xf
  v_add_f32_dpp v253, v253, v253 row_shr:1 row_mask:0xf bank_mask:0xf bound_ctrl:0
  s_nop 1
  v_add_f32_dpp v253, v253, v253 row_shr:2 row_mask:0xf bank_mask:0xf bound_ctrl:0
  s_nop 1
  v_add_f32_dpp v253, v253, v253 row_shr:4 row_mask:0xf bank_mask:0xf bound_ctrl:0
  s_nop 1
  v_add_f32_dpp v253, v253, v253 row_shr:8 row_mask:0xf bank_mask:0xf bound_ctrl:0
  s_nop 1
  v_add_f32_dpp v253, v253, v253 row_bcast:15 row_mask:0xa bank_mask:0xf
  s_nop 1
  v_add_f32_dpp v253, v253, v253 row_bcast:31 row_mask:0xc bank_mask:0xf
  s_lshl_b64 exec, 1, 63
  ds_write_b64 v249, v[252:253]
  s_mov_b64 exec, -1
L_of_101:
  s_waitcnt vmcnt(0)
L_of_101a:
  ds_read_b128 v[64:67], v8 offset:0
  ds_read_b128 v[68:71], v8 offset:1024
  ds_read_b128 v[72:75], v8 offset:2048
  ds_read_b128 v[76:79], v8 offset:3072
  s_waitcnt lgkmcnt(3)
  v_max3_u32 v64, v64, v65, v66
  v_max_u32 v64, v64, v67
  s_waitcnt lgkmcnt(2)
  v_max3_u32 v68, v68, v69, v70
  v_max_u32 v68, v68, v71
  s_waitcnt lgkmcnt(1)
  v_max3_u32 v72, v72, v73, v74
  v_max_u32 v72, v72, v75
  s_waitcnt lgkmcnt(0)
  v_max3_u32 v76, v76, v77, v78
  v_max_u32 v76, v76, v79
  v_max3_u32 v65, v64, v68, v72
  v_max_u32 v65, v65, v76
  v_cmp_eq_u32 vcc, -1, v65
  s_cbranch_vccz L_ofd_102
  v_cmp_eq_u32 vcc, -1, v64
  s_cbranch_vccz L_ofr_110
  s_add_u32 m0, s69, 0
  s_add_u32 s66, s68, 0
  buffer_load_dwordx4 v9, s[20:23], s66 offen sc1 lds
L_ofr_110:
  v_cmp_eq_u32 vcc, -1, v68
  s_cbranch_vccz L_ofr_111
  s_add_u32 m0, s69, 1024
  s_add_u32 s66, s68, 1024
  buffer_load_dwordx4 v9, s[20:23], s66 offen sc1 lds
L_ofr_111:
  v_cmp_eq_u32 vcc, -1, v72
  s_cbranch_vccz L_ofr_112
  s_add_u32 m0, s69, 2048
  s_add_u32 s66, s68, 2048
  buffer_load_dwordx4 v9, s[20:23], s66 offen sc1 lds
L_ofr_112:
  v_cmp_eq_u32 vcc, -1, v76
  s_cbranch_vccz L_ofr_113
  s_add_u32 m0, s69, 3072
  s_add_u32 s66, s68, 3072
  buffer_load_dwordx4 v9, s[20:23], s66 offen sc1 lds
L_ofr_113:
  s_cmp_eq_u32 s81, 0
  s_cbranch_scc1 L_ofd_102
  s_sub_u32 s81, s81, 1
  s_branch L_of_101
L_ofd_102:
  s_waitcnt vmcnt(0) lgkmcnt(0)
  s_barrier
  s_sub_u32 s66, s52, 1
  s_cmp_ge_u32 s66, 2
  s_cbranch_scc1 L_vw_114
  v_lshlrev_b32 v6, 2, v6
  v_add_u32 v6, 135168, v6
  ds_write_b32 v6, v20
  ds_write_b32 v6, v28 offset:512
  ds_write_b32 v6, v24 offset:1024
  ds_write_b32 v6, v22 offset:1536
  ds_write_b32 v6, v26 offset:2048
L_vw_114:
  s_lshl_b32 s66, s63, 15
  v_lshl_add_u32 v5, v1, 4, s66
  ds_read_b128 v[64:67], v5 offset:16384
  ds_read_b128 v[68:71], v5 offset:17408
  ds_read_b128 v[72:75], v5 offset:18432
  ds_read_b128 v[76:79], v5 offset:19456
  ds_read_b128 v[80:83], v5 offset:20480
  ds_read_b128 v[84:87], v5 offset:21504
  ds_read_b128 v[88:91], v5 offset:22528
  ds_read_b128 v[92:95], v5 offset:23552
  ds_read_b128 v[96:99], v5 offset:24576
  ds_read_b128 v[100:103], v5 offset:25600
  ds_read_b128 v[104:107], v5 offset:26624
  ds_read_b128 v[108:111], v5 offset:27648
  ds_read_b128 v[112:115], v5 offset:28672
  ds_read_b128 v[116:119], v5 offset:29696
  ds_read_b128 v[120:123], v5 offset:30720
  ds_read_b128 v[124:127], v5 offset:31744
  s_waitcnt lgkmcnt(12)
  v_mfma_f32_32x32x16_bf16 v[16:31], v[176:179], v[64:67], 0
  v_mfma_f32_32x32x16_bf16 v[16:31], v[180:183], v[68:71], v[16:31]
  v_mfma_f32_32x32x16_bf16 v[16:31], v[184:187], v[72:75], v[16:31]
  v_mfma_f32_32x32x16_bf16 v[16:31], v[188:191], v[76:79], v[16:31]
  s_waitcnt lgkmcnt(8)
  v_mfma_f32_32x32x16_bf16 v[16:31], v[192:195], v[80:83], v[16:31]
  v_mfma_f32_32x32x16_bf16 v[16:31], v[196:199], v[84:87], v[16:31]
  v_mfma_f32_32x32x16_bf16 v[16:31], v[200:203], v[88:91], v[16:31]
  v_mfma_f32_32x32x16_bf16 v[16:31], v[204:207], v[92:95], v[16:31]
  s_waitcnt lgkmcnt(4)
  v_mfma_f32_32x32x16_bf16 v[16:31], v[208:211], v[96:99], v[16:31]
  v_mfma_f32_32x32x16_bf16 v[16:31], v[212:215], v[100:103], v[16:31]
  v_mfma_f32_32x32x16_bf16 v[16:31], v[216:219], v[104:107], v[16:31]
  v_mfma_f32_32x32x16_bf16 v[16:31], v[220:223], v[108:111], v[16:31]
  s_waitcnt lgkmcnt(0)
  v_mfma_f32_32x32x16_bf16 v[16:31], v[224:227], v[112:115], v[16:31]
  v_mfma_f32_32x32x16_bf16 v[16:31], v[228:231], v[116:119], v[16:31]
  v_mfma_f32_32x32x16_bf16 v[16:31], v[232:235], v[120:123], v[16:31]
  v_mfma_f32_32x32x16_bf16 v[16:31], v[236:239], v[124:127], v[16:31]
  s_lshl_b32 s66, s64, 12
  s_add_u32 s66, s66, 32768
  v_lshl_add_u32 v5, v1, 4, s66
  s_nop 7
  s_cmp_eq_u32 s63, 1
  s_cbranch_scc1 L_x1_115
  ds_write_b128 v5, v[24:27] offset:2048
  ds_write_b128 v5, v[28:31] offset:3072
  s_branch L_xj_116
L_x1_115:
  ds_write_b128 v5, v[16:19]
  ds_write_b128 v5, v[20:23] offset:1024
  v_mov_b32 v16, v24
  v_mov_b32 v17, v25
  v_mov_b32 v18, v26
  v_mov_b32 v19, v27
  v_mov_b32 v20, v28
  v_mov_b32 v21, v29
  v_mov_b32 v22, v30
  v_mov_b32 v23, v31
L_xj_116:
  s_lshl_b32 s66, s63, 11
  v_add_u32 v5, s66, v5
  s_lshl_b32 s66, s64, 7
  s_lshl_b32 s67, s63, 5
  s_add_u32 s66, s66, s67
  s_add_u32 s66, s66, 135168
  v_lshrrev_b32 v6, 5, v1
  v_lshl_add_u32 v61, v6, 6, s66
  s_waitcnt lgkmcnt(0)
  s_barrier
  ds_read_b128 v[32:35], v5
  ds_read_b128 v[36:39], v5 offset:1024
  ds_read_b128 v[64:67], v61
  ds_read_b128 v[68:71], v61 offset:16
  ds_read_b128 v[72:75], v61 offset:512
  ds_read_b128 v[76:79], v61 offset:528
  s_waitcnt lgkmcnt(4)
  v_add_f32 v16, v16, v32
  v_add_f32 v17, v17, v33
  v_add_f32 v18, v18, v34
  v_add_f32 v19, v19, v35
  v_add_f32 v20, v20, v36
  v_add_f32 v21, v21, v37
  v_add_f32 v22, v22, v38
  v_add_f32 v23, v23, v39
  v_cvt_pk_bf16_f32 v16, v16, v17
  v_and_b32 v17, s80, v16
  v_lshlrev_b32 v16, 16, v16
  v_cvt_pk_bf16_f32 v18, v18, v19
  v_and_b32 v19, s80, v18
  v_lshlrev_b32 v18, 16, v18
  v_cvt_pk_bf16_f32 v20, v20, v21
  v_and_b32 v21, s80, v20
  v_lshlrev_b32 v20, 16, v20
  v_cvt_pk_bf16_f32 v22, v22, v23
  v_and_b32 v23, s80, v22
  v_lshlrev_b32 v22, 16, v22
  s_waitcnt lgkmcnt(0)
  v_mul_f32 v16, v16, v64
  v_mul_f32 v17, v17, v65
  v_mul_f32 v18, v18, v66
  v_mul_f32 v19, v19, v67
  v_mul_f32 v20, v20, v68
  v_mul_f32 v21, v21, v69
  v_mul_f32 v22, v22, v70
  v_mul_f32 v23, v23, v71
  v_cvt_pk_bf16_f32 v16, v16, v17
  v_and_b32 v17, s80, v16
  v_lshlrev_b32 v16, 16, v16
  v_cvt_pk_bf16_f32 v18, v18, v19
  v_and_b32 v19, s80, v18
  v_lshlrev_b32 v18, 16, v18
  v_cvt_pk_bf16_f32 v20, v20, v21
  v_and_b32 v21, s80, v20
  v_lshlrev_b32 v20, 16, v20
  v_cvt_pk_bf16_f32 v22, v22, v23
  v_and_b32 v23, s80, v22
  v_lshlrev_b32 v22, 16, v22
  v_lshlrev_b32 v32, 16, v156
  v_and_b32 v33, s80, v156
  v_lshlrev_b32 v34, 16, v157
  v_and_b32 v35, s80, v157
  v_lshlrev_b32 v36, 16, v158
  v_and_b32 v37, s80, v158
  v_lshlrev_b32 v38, 16, v159
  v_and_b32 v39, s80, v159
  v_add_f32 v16, v16, v32
  v_add_f32 v17, v17, v33
  v_add_f32 v18, v18, v34
  v_add_f32 v19, v19, v35
  v_add_f32 v20, v20, v36
  v_add_f32 v21, v21, v37
  v_add_f32 v22, v22, v38
  v_add_f32 v23, v23, v39
  v_cvt_pk_bf16_f32 v16, v16, v17
  v_and_b32 v17, s80, v16
  v_lshlrev_b32 v16, 16, v16
  v_cvt_pk_bf16_f32 v18, v18, v19
  v_and_b32 v19, s80, v18
  v_lshlrev_b32 v18, 16, v18
  v_cvt_pk_bf16_f32 v20, v20, v21
  v_and_b32 v21, s80, v20
  v_lshlrev_b32 v20, 16, v20
  v_cvt_pk_bf16_f32 v22, v22, v23
  v_and_b32 v23, s80, v22
  v_lshlrev_b32 v22, 16, v22
  s_lshl_b32 s66, s64, 7
  s_lshl_b32 s67, s63, 5
  s_add_u32 s66, s66, s67
  s_add_u32 s66, s66, 65536
  v_and_b32 v6, 31, v1
  v_mul_u32_u24 v7, 528, v6
  v_lshrrev_b32 v8, 5, v1
  v_lshl_add_u32 v7, v8, 6, v7
  v_add_u32 v7, s66, v7
  v_mov_b32 v40, v16
  v_mul_f32 v41, v16, v16
  v_mul_f32 v42, v16, v72
  ds_write_b128 v7, v[16:19]
  ds_write_b128 v7, v[20:23] offset:16
  v_add_f32 v40, v40, v17
  v_fmac_f32 v41, v17, v17
  v_fmac_f32 v42, v17, v73
  v_add_f32 v40, v40, v18
  v_fmac_f32 v41, v18, v18
  v_fmac_f32 v42, v18, v74
  v_add_f32 v40, v40, v19
  v_fmac_f32 v41, v19, v19
  v_fmac_f32 v42, v19, v75
  v_add_f32 v40, v40, v20
  v_fmac_f32 v41, v20, v20
  v_fmac_f32 v42, v20, v76
  v_add_f32 v40, v40, v21
  v_fmac_f32 v41, v21, v21
  v_fmac_f32 v42, v21, v77
  v_add_f32 v40, v40, v22
  v_fmac_f32 v41, v22, v22
  v_fmac_f32 v42, v22, v78
  v_add_f32 v40, v40, v23
  v_fmac_f32 v41, v23, v23
  v_fmac_f32 v42, v23, v79
  v_mov_b32 v44, v40
  v_mov_b32 v45, v41
  v_mov_b32 v46, v42
  s_lshl_b32 s66, s52, 9
  v_permlane32_swap_b32 v40, v44
  v_permlane32_swap_b32 v41, v45
  v_permlane32_swap_b32 v42, v46
  s_add_u32 s66, s66, 139264
  v_add_f32 v40, v40, v44
  v_add_f32 v41, v41, v45
  v_add_f32 v42, v42, v46
  v_lshl_add_u32 v5, v6, 4, s66
  s_mov_b64 exec, s[100:101]
  ds_write_b128 v5, v[40:43]
  s_mov_b64 exec, -1
  s_and_b32 s66, s60, 3
  s_lshl_b32 s66, s66, 11
  s_lshr_b32 s67, s60, 2
  s_and_b32 s67, s67, 7
  s_lshl_b32 s67, s67, 14
  s_add_u32 s66, s66, s67
  s_lshr_b32 s67, s60, 5
  s_lshl_b32 s67, s67, 13
  s_xor_b32 s67, s67, s0
  s_add_u32 s66, s66, s67
  s_add_u32 s66, s66, 262144
  v_lshlrev_b32 v9, 4, v6
  v_lshl_add_u32 v9, v8, 10, v9
  v_add_u32 v9, s66, v9
  v_and_b32 v11, 7, v1
  v_lshlrev_b32 v11, 3, v11
  v_add_u32 v11, 146432, v11
  s_waitcnt lgkmcnt(0)
  s_barrier
  s_cmp_lg_u32 s52, 0
  s_cbranch_scc1 L_sp_117
  s_setprio 3
  v_lshlrev_b32 v5, 4, v6
  v_add_u32 v5, 139264, v5
  ds_read_b128 v[64:67], v5 offset:0
  ds_read_b128 v[68:71], v5 offset:512
  ds_read_b128 v[72:75], v5 offset:1024
  ds_read_b128 v[76:79], v5 offset:1536
  ds_read_b128 v[80:83], v5 offset:2048
  ds_read_b128 v[84:87], v5 offset:2560
  ds_read_b128 v[88:91], v5 offset:3072
  ds_read_b128 v[92:95], v5 offset:3584
  s_lshl_b32 s67, s61, 9
  s_add_u32 s66, s66, s67
  v_lshl_add_u32 v5, v6, 4, s66
  s_waitcnt lgkmcnt(4)
  v_add_f32 v64, v64, v68
  v_add_f32 v65, v65, v69
  v_add_f32 v66, v66, v70
  v_add_f32 v72, v72, v76
  v_add_f32 v73, v73, v77
  v_add_f32 v74, v74, v78
  s_waitcnt lgkmcnt(0)
  v_add_f32 v80, v80, v84
  v_add_f32 v81, v81, v85
  v_add_f32 v82, v82, v86
  v_add_f32 v88, v88, v92
  v_add_f32 v89, v89, v93
  v_add_f32 v90, v90, v94
  v_add_f32 v64, v64, v72
  v_add_f32 v65, v65, v73
  v_add_f32 v66, v66, v74
  v_add_f32 v80, v80, v88
  v_add_f32 v81, v81, v89
  v_add_f32 v82, v82, v90
  v_add_f32 v64, v64, v80
  v_add_f32 v65, v65, v81
  v_add_f32 v66, v66, v82
  v_mov_b32 v67, s53
  s_mov_b64 exec, s[100:101]
  buffer_store_dwordx4 v[64:67], v5, s[20:23], 0 offen sc1
  s_mov_b64 exec, -1
  s_setprio 0
L_sp_117:
  ds_read_b128 v[64:67], v61 offset:1024
  ds_read_b128 v[68:71], v61 offset:1040
  ds_read_b128 v[72:75], v61 offset:1536
  ds_read_b128 v[76:79], v61 offset:1552
  ds_read_b128 v[80:83], v61 offset:2048
  ds_read_b128 v[84:87], v61 offset:2064
  v_lshlrev_b32 v12, 3, v6
  v_add_u32 v12, 146688, v12
  s_cmp_lg_u32 s52, 1
  s_cbranch_scc1 L_sw_120
  s_setprio 3
  ds_read_b64 v[44:45], v11
  buffer_load_dwordx4 v[32:35], v9, s[20:23], 0 offen sc1
  buffer_load_dwordx4 v[36:39], v9, s[20:23], 0 offen offset:512 sc1
  s_waitcnt lgkmcnt(0)
  v_add_f32_dpp v44, v44, v44 row_ror:4 row_mask:0xf bank_mask:0xf
  v_add_f32_dpp v45, v45, v45 row_ror:4 row_mask:0xf bank_mask:0xf
  s_nop 0
  v_add_f32_dpp v44, v44, v44 row_ror:2 row_mask:0xf bank_mask:0xf
  v_add_f32_dpp v45, v45, v45 row_ror:2 row_mask:0xf bank_mask:0xf
  s_nop 0
  v_add_f32_dpp v44, v44, v44 row_ror:1 row_mask:0xf bank_mask:0xf
  v_add_f32_dpp v45, v45, v45 row_ror:1 row_mask:0xf bank_mask:0xf
  s_lshl_b32 s66, s60, 5
  s_sub_u32 s66, 2047, s66
  v_sub_u32 v47, s66, v6
  v_mov_b32 v59, s53
  v_mov_b32 v7, 146944
  s_lshl_b32 s66, s60, 7
  s_add_u32 s66, s66, 786432
  v_lshl_add_u32 v5, v1, 13, s66
L_sq_118:
  s_waitcnt vmcnt(0)
  v_cmp_eq_u32 vcc, s53, v35
  v_cmp_eq_u32 s[72:73], s53, v39
  s_nop 0
  s_and_b64 vcc, vcc, s[72:73]
  s_cmp_eq_u64 vcc, exec
  s_cbranch_scc1 L_sqd_119
  s_cmp_eq_u32 s81, 0
  s_cbranch_scc1 L_sqd_119
  s_sub_u32 s81, s81, 1
  buffer_load_dwordx4 v[32:35], v9, s[20:23], 0 offen sc1
  buffer_load_dwordx4 v[36:39], v9, s[20:23], 0 offen offset:512 sc1
  s_branch L_sq_118
L_sqd_119:
  v_add_f32 v32, v32, v36
  v_add_f32 v33, v33, v37
  v_add_f32 v34, v34, v38
  v_mov_b32 v36, v32
  v_mov_b32 v37, v33
  v_mov_b32 v38, v34
  s_waitcnt lgkmcnt(0)
  v_permlane32_swap_b32 v32, v36
  v_permlane32_swap_b32 v33, v37
  v_permlane32_swap_b32 v34, v38
  v_add_f32 v32, v32, v36
  v_add_f32 v33, v33, v37
  v_add_f32 v40, v34, v38
  v_mul_f32 v10, 0x3b000000, v32
  v_mul_f32 v11, 0x3b000000, v33
  v_fma_f32 v11, -v10, v10, v11
  v_max_f32 v11, 0, v11
  v_cvt_pk_bf16_f32 v10, v10, v10
  v_lshlrev_b32 v10, 16, v10
  v_cvt_pk_bf16_f32 v11, v11, v11
  v_lshlrev_b32 v11, 16, v11
  v_add_f32 v11, 0x3727c5ac, v11
  v_cvt_pk_bf16_f32 v11, v11, v11
  v_lshlrev_b32 v11, 16, v11
  v_sqrt_f32 v11, v11
  s_nop 0
  v_cvt_pk_bf16_f32 v11, v11, v11
  v_lshlrev_b32 v11, 16, v11
  v_rcp_f32 v52, v11
  s_nop 0
  v_mul_f32 v53, v10, v52
  v_sub_f32 v53, 0, v53
  v_mov_b32 v54, v10
  v_fma_f32 v45, v53, v44, v45
  v_fma_f32 v45, v52, v40, v45
  ds_write2_b32 v12, v52, v54 offset1:1
  v_cvt_pk_bf16_f32 v45, v45, v45
  v_lshlrev_b32 v45, 16, v45
  v_ashrrev_i32 v46, 31, v45
  v_or_b32 v46, 0x80000000, v46
  v_xor_b32 v46, v45, v46
  v_and_b32 v46, s80, v46
  v_or_b32 v55, v46, v47
  s_nop 1
  v_max_u32_dpp v55, v55, v55 row_ror:8 row_mask:0xf bank_mask:0xf
  s_nop 1
  v_max_u32_dpp v55, v55, v55 row_ror:4 row_mask:0xf bank_mask:0xf
  s_nop 1
  v_max_u32_dpp v55, v55, v55 row_ror:2 row_mask:0xf bank_mask:0xf
  s_nop 1
  v_max_u32_dpp v55, v55, v55 row_ror:1 row_mask:0xf bank_mask:0xf
  v_mov_b32 v56, v55
  s_nop 1
  v_permlane16_swap_b32 v55, v56
  v_max_u32 v55, v55, v56
  v_mov_b32 v58, v55
  s_mov_b64 exec, 0xff
  s_cmp_lg_u32 s61, 0
  s_cbranch_scc1 L_bp_121
  buffer_store_dwordx2 v[58:59], v5, s[20:23], 0 offen sc1
L_bp_121:
  s_mov_b64 exec, 1
  ds_write_b32 v7, v55
  s_mov_b64 exec, -1
  s_waitcnt lgkmcnt(0)
  s_setprio 0
L_sw_120:
  s_barrier
  s_cmp_eq_u32 s52, 1
  s_cbranch_scc1 L_ko_124
  ds_read_b32 v52, v12
  ds_read_b32 v54, v12 offset:4
  s_cmp_eq_u32 s52, 2
  s_cbranch_scc1 L_k2_123
  s_cmp_lg_u32 s52, 3
  s_cbranch_scc1 L_k1_122
  s_setprio 3
  s_and_b32 s66, s54, 3
  s_lshl_b32 s66, s66, 14
  s_lshr_b32 s67, s54, 2
  s_lshl_b32 s67, s67, 13
  s_xor_b32 s67, s67, s0
  s_add_u32 s66, s66, s67
  s_add_u32 s66, s66, 786432
  v_lshl_add_u32 v5, v1, 7, s66
  buffer_load_dwordx2 v[56:57], v5, s[20:23], 0 offen sc1
  s_branch L_k1_122
L_k2_123:
  s_setprio 3
  v_mov_b32 v7, 146944
  ds_read_b32 v55, v7
  v_lshlrev_b32 v8, 3, v1
  v_add_u32 v9, 135168, v8
  ds_read_b64 v[34:35], v9 offset:1024
  ds_read_b64 v[36:37], v9 offset:1536
  s_mov_b32 s70, s60
  s_lshl_b32 s70, s70, 12
  s_add_u32 s70, s70, 524288
  s_lshl_b32 s71, s61, 10
  s_add_u32 s70, s70, s71
  s_waitcnt lgkmcnt(2)
  v_readfirstlane_b32 s66, v55
  s_nop 0
  s_and_b32 s66, s66, 31
  s_sub_u32 s66, 31, s66
  s_mul_i32 s67, s66, 528
  s_add_u32 s67, s67, 65536
  v_add_u32 v9, s67, v8
  ds_read_b64 v[32:33], v9
  v_readlane_b32 s68, v54, s66
  v_readlane_b32 s69, v52, s66
  v_lshl_add_u32 v8, v1, 4, s70
  s_waitcnt lgkmcnt(0)
  v_subrev_f32 v38, s68, v32
  v_subrev_f32 v39, s68, v33
  v_cvt_pk_bf16_f32 v38, v38, v39
  v_and_b32 v39, s80, v38
  v_lshlrev_b32 v38, 16, v38
  v_mul_f32 v38, s69, v38
  v_mul_f32 v39, s69, v39
  v_cvt_pk_bf16_f32 v38, v38, v39
  v_and_b32 v39, s80, v38
  v_lshlrev_b32 v38, 16, v38
  v_mul_f32 v38, v38, v34
  v_mul_f32 v39, v39, v35
  v_cvt_pk_bf16_f32 v38, v38, v39
  v_and_b32 v39, s80, v38
  v_lshlrev_b32 v38, 16, v38
  v_add_f32 v38, v38, v36
  v_add_f32 v39, v39, v37
  v_cvt_pk_bf16_f32 v38, v38, v39
  v_and_b32 v48, 0xffff, v38
  v_or_b32 v48, v48, v32
  v_lshrrev_b32 v50, 16, v38
  v_or_b32 v50, v50, v33
  v_mov_b32 v49, s53
  v_mov_b32 v51, s53
  buffer_store_dwordx4 v[48:51], v8, s[20:23], 0 offen sc1
  s_setprio 0
L_k1_122:
  s_waitcnt lgkmcnt(0)
L_ko_124:
  v_sub_f32 v32, v16, v54
  v_sub_f32 v33, v17, v54
  v_sub_f32 v34, v18, v54
  v_sub_f32 v35, v19, v54
  v_sub_f32 v36, v20, v54
  v_sub_f32 v37, v21, v54
  v_sub_f32 v38, v22, v54
  v_sub_f32 v39, v23, v54
  v_cvt_pk_bf16_f32 v32, v32, v33
  v_and_b32 v33, s80, v32
  v_lshlrev_b32 v32, 16, v32
  v_cvt_pk_bf16_f32 v34, v34, v35
  v_and_b32 v35, s80, v34
  v_lshlrev_b32 v34, 16, v34
  v_cvt_pk_bf16_f32 v36, v36, v37
  v_and_b32 v37, s80, v36
  v_lshlrev_b32 v36, 16, v36
  v_cvt_pk_bf16_f32 v38, v38, v39
  v_and_b32 v39, s80, v38
  v_lshlrev_b32 v38, 16, v38
  v_mul_f32 v32, v32, v52
  v_mul_f32 v33, v33, v52
  v_mul_f32 v34, v34, v52
  v_mul_f32 v35, v35, v52
  v_mul_f32 v36, v36, v52
  v_mul_f32 v37, v37, v52
  v_mul_f32 v38, v38, v52
  v_mul_f32 v39, v39, v52
  v_cvt_pk_bf16_f32 v32, v32, v33
  v_and_b32 v33, s80, v32
  v_lshlrev_b32 v32, 16, v32
  v_cvt_pk_bf16_f32 v34, v34, v35
  v_and_b32 v35, s80, v34
  v_lshlrev_b32 v34, 16, v34
  v_cvt_pk_bf16_f32 v36, v36, v37
  v_and_b32 v37, s80, v36
  v_lshlrev_b32 v36, 16, v36
  v_cvt_pk_bf16_f32 v38, v38, v39
  v_and_b32 v39, s80, v38
  v_lshlrev_b32 v38, 16, v38
  s_waitcnt lgkmcnt(0)
  v_mul_f32 v32, v32, v64
  v_mul_f32 v33, v33, v65
  v_mul_f32 v34, v34, v66
  v_mul_f32 v35, v35, v67
  v_mul_f32 v36, v36, v68
  v_mul_f32 v37, v37, v69
  v_mul_f32 v38, v38, v70
  v_mul_f32 v39, v39, v71
  v_cvt_pk_bf16_f32 v32, v32, v33
  v_and_b32 v33, s80, v32
  v_lshlrev_b32 v32, 16, v32
  v_cvt_pk_bf16_f32 v34, v34, v35
  v_and_b32 v35, s80, v34
  v_lshlrev_b32 v34, 16, v34
  v_cvt_pk_bf16_f32 v36, v36, v37
  v_and_b32 v37, s80, v36
  v_lshlrev_b32 v36, 16, v36
  v_cvt_pk_bf16_f32 v38, v38, v39
  v_and_b32 v39, s80, v38
  v_lshlrev_b32 v38, 16, v38
  v_add_f32 v32, v32, v72
  v_add_f32 v33, v33, v73
  v_add_f32 v34, v34, v74
  v_add_f32 v35, v35, v75
  v_add_f32 v36, v36, v76
  v_add_f32 v37, v37, v77
  v_add_f32 v38, v38, v78
  v_add_f32 v39, v39, v79
  v_cvt_pk_bf16_f32 v32, v32, v33
  v_and_b32 v33, s80, v32
  v_lshlrev_b32 v32, 16, v32
  v_cvt_pk_bf16_f32 v34, v34, v35
  v_and_b32 v35, s80, v34
  v_lshlrev_b32 v34, 16, v34
  v_cvt_pk_bf16_f32 v36, v36, v37
  v_and_b32 v37, s80, v36
  v_lshlrev_b32 v36, 16, v36
  v_cvt_pk_bf16_f32 v38, v38, v39
  v_and_b32 v39, s80, v38
  v_lshlrev_b32 v38, 16, v38
  v_mul_f32 v40, v32, v80
  v_mul_f32 v41, v33, v81
  v_mul_f32 v42, v34, v82
  v_mul_f32 v43, v35, v83
  v_mul_f32 v44, v36, v84
  v_mul_f32 v45, v37, v85
  v_mul_f32 v46, v38, v86
  v_mul_f32 v47, v39, v87
  v_cvt_pk_bf16_f32 v40, v40, v41
  v_and_b32 v41, s80, v40
  v_lshlrev_b32 v40, 16, v40
  v_cvt_pk_bf16_f32 v42, v42, v43
  v_and_b32 v43, s80, v42
  v_lshlrev_b32 v42, 16, v42
  v_cvt_pk_bf16_f32 v44, v44, v45
  v_and_b32 v45, s80, v44
  v_lshlrev_b32 v44, 16, v44
  v_cvt_pk_bf16_f32 v46, v46, v47
  v_and_b32 v47, s80, v46
  v_lshlrev_b32 v46, 16, v46
  v_add_f32 v40, v40, v16
  v_add_f32 v41, v41, v17
  v_add_f32 v42, v42, v18
  v_add_f32 v43, v43, v19
  v_add_f32 v44, v44, v20
  v_add_f32 v45, v45, v21
  v_add_f32 v46, v46, v22
  v_add_f32 v47, v47, v23
  v_cvt_pk_bf16_f32 v88, v40, v41
  v_cvt_pk_bf16_f32 v89, v42, v43
  v_cvt_pk_bf16_f32 v90, v44, v45
  v_cvt_pk_bf16_f32 v91, v46, v47
  s_lshl_b32 s66, s64, 6
  s_lshl_b32 s67, s63, 4
  s_add_u32 s66, s66, s67
  s_add_u32 s66, s66, 32768
  v_and_b32 v6, 31, v1
  v_mul_u32_u24 v7, 272, v6
  v_lshrrev_b32 v8, 5, v1
  v_lshl_add_u32 v7, v8, 5, v7
  v_add_u32 v7, s66, v7
  ds_write_b128 v7, v[88:91]
  s_lshl_b32 s67, s52, 2
  v_lshrrev_b32 v63, 4, v1
  v_add_u32 v63, s67, v63
  v_and_b32 v8, 15, v1
  v_lshlrev_b32 v8, 4, v8
  v_mul_u32_u24 v62, 272, v63
  v_add_u32 v62, v62, v8
  v_add_u32 v62, 32768, v62
  s_lshl_b32 s67, s60, 15
  s_lshl_b32 s70, s61, 8
  s_add_u32 s67, s67, s70
  v_lshl_add_u32 v161, v63, 10, v8
  v_add_u32 v161, s67, v161
  v_lshrrev_b32 v7, 4, v1
  v_lshlrev_b32 v7, 3, v7
  s_lshl_b32 s66, s52, 7
  s_add_u32 s66, s66, 145408
  v_add_u32 v7, s66, v7
  v_mov_b32 v4, 150528
  s_cmp_lg_u32 s52, 3
  s_cbranch_scc1 L_bqd_127
  s_mov_b32 s76, 0
  v_lshlrev_b32 v6, 4, v1
L_bq_125:
  s_waitcnt vmcnt(0)
L_bq_125b:
  v_cmp_eq_u32 vcc, s53, v57
  s_nop 1
  v_cndmask_b32 v32, 0, v56, vcc
  s_nop 1
  v_max_u32_dpp v32, v32, v32 row_ror:8 row_mask:0xf bank_mask:0xf
  s_nop 1
  v_max_u32_dpp v32, v32, v32 row_ror:4 row_mask:0xf bank_mask:0xf
  s_nop 1
  v_max_u32_dpp v32, v32, v32 row_ror:2 row_mask:0xf bank_mask:0xf
  s_nop 1
  v_max_u32_dpp v32, v32, v32 row_ror:1 row_mask:0xf bank_mask:0xf
  v_mov_b32 v33, v32
  s_nop 1
  v_permlane16_swap_b32 v32, v33
  v_max_u32 v32, v32, v33
  v_mov_b32 v33, v32
  s_nop 1
  v_permlane32_swap_b32 v32, v33
  v_max_u32 v32, v32, v33
  s_nop 0
  v_readfirstlane_b32 s77, v32
  s_cmp_eq_u64 vcc, exec
  s_cbranch_scc1 L_bf_126
  buffer_load_dwordx2 v[56:57], v5, s[20:23], 0 offen sc1
  s_cmp_eq_u32 s81, 0
  s_cbranch_scc1 L_bf_126
  s_sub_u32 s81, s81, 1
  s_cmp_lg_u32 s92, 0
  s_cbranch_scc1 L_bq_125
  s_cmp_eq_u32 s77, s76
  s_cbranch_scc1 L_bq_125
  s_mov_b32 s76, s77
  s_and_b32 s66, s76, 2047
  s_sub_u32 s66, 2047, s66
  s_lshr_b32 s66, s66, 5
  s_lshl_b32 s66, s66, 12
  s_add_u32 s66, s66, 524288
  buffer_load_dwordx4 v[96:99], v6, s[20:23], s66 offen offset:0 sc1
  buffer_load_dwordx4 v[100:103], v6, s[20:23], s66 offen offset:1024 sc1
  buffer_load_dwordx4 v[104:107], v6, s[20:23], s66 offen offset:2048 sc1
  buffer_load_dwordx4 v[108:111], v6, s[20:23], s66 offen offset:3072 sc1
  s_waitcnt vmcnt(4)
  s_branch L_bq_125b
L_bf_126:
  v_mov_b32 v5, 150528
  ds_write_b32 v5, v32
  s_cmp_lg_u32 s92, 0
  s_cbranch_scc1 L_bg_130
  s_cmp_eq_u32 s77, s76
  s_cbranch_scc1 L_bc_129
L_br_131:
  s_and_b32 s66, s77, 2047
  s_sub_u32 s66, 2047, s66
  s_lshr_b32 s66, s66, 5
  s_lshl_b32 s66, s66, 12
  s_add_u32 s66, s66, 524288
  buffer_load_dwordx4 v[96:99], v6, s[20:23], s66 offen offset:0 sc1
  buffer_load_dwordx4 v[100:103], v6, s[20:23], s66 offen offset:1024 sc1
  buffer_load_dwordx4 v[104:107], v6, s[20:23], s66 offen offset:2048 sc1
  buffer_load_dwordx4 v[108:111], v6, s[20:23], s66 offen offset:3072 sc1
L_bc_129:
  s_waitcnt vmcnt(0)
  v_cmp_eq_u32 vcc, s53, v97
  v_cmp_eq_u32 s[72:73], s53, v99
  s_nop 0
  s_and_b64 vcc, vcc, s[72:73]
  v_cmp_eq_u32 s[72:73], s53, v101
  s_nop 0
  s_and_b64 vcc, vcc, s[72:73]
  v_cmp_eq_u32 s[72:73], s53, v103
  s_nop 0
  s_and_b64 vcc, vcc, s[72:73]
  v_cmp_eq_u32 s[72:73], s53, v105
  s_nop 0
  s_and_b64 vcc, vcc, s[72:73]
  v_cmp_eq_u32 s[72:73], s53, v107
  s_nop 0
  s_and_b64 vcc, vcc, s[72:73]
  v_cmp_eq_u32 s[72:73], s53, v109
  s_nop 0
  s_and_b64 vcc, vcc, s[72:73]
  v_cmp_eq_u32 s[72:73], s53, v111
  s_nop 0
  s_and_b64 vcc, vcc, s[72:73]
  s_cmp_eq_u64 vcc, exec
  s_cbranch_scc1 L_bc_129k
  s_cmp_eq_u32 s81, 0
  s_cbranch_scc1 L_bc_129k
  s_sub_u32 s81, s81, 1
  s_branch L_br_131
L_bc_129k:
  s_mov_b32 s66, 0x05040100
  v_perm_b32 v32, v98, v96, s66
  v_perm_b32 v33, v102, v100, s66
  v_perm_b32 v34, v106, v104, s66
  v_perm_b32 v35, v110, v108, s66
  v_lshlrev_b32 v5, 2, v1
  v_add_u32 v5, 145408, v5
  ds_write2st64_b32 v5, v32, v33 offset1:1
  ds_write2st64_b32 v5, v34, v35 offset0:2 offset1:3
L_bg_130:
  s_waitcnt lgkmcnt(0)
  s_setprio 0
L_bqd_127:
  s_waitcnt lgkmcnt(0)
  s_barrier
  ds_read_b32 v32, v4
  ds_read_b64 v[72:73], v7 offset:0
  ds_read_b64 v[74:75], v7 offset:32
  ds_read_b64 v[76:77], v7 offset:64
  ds_read_b64 v[78:79], v7 offset:96
  s_waitcnt lgkmcnt(4)
  v_readfirstlane_b32 s96, v32
  s_nop 0
  s_and_b32 s66, s96, 2047
  s_sub_u32 s97, 2047, s66
  s_lshr_b32 s66, s97, 5
  s_cmp_eq_u32 s66, s60
  s_cselect_b64 s[68:69], -1, 0
  s_and_b32 s66, s97, 31
  ds_read_b128 v[88:91], v62
  v_cmp_eq_u32 s[98:99], s66, v63
  s_nop 0
  s_and_b64 s[98:99], s[98:99], s[68:69]
  s_lshr_b32 s66, s97, 5
  s_lshl_b32 s66, s66, 12
  s_add_u32 s66, s66, 524288
  s_cmp_eq_u32 s92, 1
  s_cbranch_scc1 L_dn_132
  s_lshl_b32 s66, s52, 6
  s_add_u32 s66, s66, 149504
  v_and_b32 v48, 15, v1
  v_lshl_add_u32 v49, v48, 2, s66
  v_lshlrev_b32 v48, 2, v48
  v_add_u32 v48, 149504, v48
  s_waitcnt lgkmcnt(2)
  v_mfma_f32_16x16x32_bf16 v[32:35], v[72:75], v[128:131], 0
  s_waitcnt lgkmcnt(0)
  v_mfma_f32_16x16x32_bf16 v[32:35], v[76:79], v[132:135], v[32:35]
  s_nop 7
  s_mov_b64 exec, 0xffff
  ds_write_b32 v49, v32
  s_mov_b64 exec, -1
  s_waitcnt lgkmcnt(0)
  s_barrier
  ds_read_b32 v64, v48 offset:0
  ds_read_b32 v65, v48 offset:64
  ds_read_b32 v66, v48 offset:128
  ds_read_b32 v67, v48 offset:192
  ds_read_b32 v68, v48 offset:256
  ds_read_b32 v69, v48 offset:320
  ds_read_b32 v70, v48 offset:384
  ds_read_b32 v71, v48 offset:448
  s_waitcnt lgkmcnt(0)
  v_add_f32 v64, v64, v65
  v_add_f32 v66, v66, v67
  v_add_f32 v68, v68, v69
  v_add_f32 v70, v70, v71
  v_add_f32 v64, v64, v66
  v_add_f32 v68, v68, v70
  v_add_f32 v32, v64, v68
  s_cmp_lg_u32 s52, 0
  s_cbranch_scc1 L_act_135
  v_cvt_pk_bf16_f32 v32, v32, v32
  v_lshlrev_b32 v32, 16, v32
  s_nop 1
  v_mov_b32_dpp v33, v32 row_ror:8 row_mask:0xf bank_mask:0xf
  v_mul_f32 v34, 0xbfb8aa3b, v32
  v_exp_f32 v34, v34
  s_nop 0
  v_add_f32 v34, 1.0, v34
  v_rcp_f32 v34, v34
  s_nop 0
  v_mul_f32 v34, v32, v34
  v_cvt_pk_bf16_f32 v34, v34, v34
  v_lshlrev_b32 v34, 16, v34
  v_mul_f32 v34, v34, v33
  v_cvt_pk_bf16_f32 v34, v34, v34
  v_lshlrev_b32 v34, 16, v34
  s_nop 1
  v_mov_b32_dpp v36, v34 quad_perm:[1,0,3,2] row_mask:0xf bank_mask:0xf
  v_mov_b32 v35, s53
  s_lshl_b32 s66, s93, 5
  s_xor_b32 s67, s0, 8192
  s_add_u32 s66, s66, s67
  s_add_u32 s66, s66, 131072
  v_lshrrev_b32 v34, 16, v34
  v_or_b32 v34, v34, v36
  v_lshl_add_u32 v5, v1, 2, s66
  s_mov_b64 exec, 0x55
  buffer_store_dwordx2 v[34:35], v5, s[20:23], 0 offen sc1
  s_mov_b64 exec, -1
L_act_135:
  s_barrier
  s_waitcnt lgkmcnt(0)
  s_andn2_b64 exec, exec, s[98:99]
  s_cbranch_execz L_os_136
  buffer_store_dwordx4 v[88:91], v161, s[24:27], 0 offen sc1
L_os_136:
  s_mov_b64 exec, -1
  s_branch L_fin
L_dn_132:
  s_lshl_b32 s67, s93, 7
  s_add_u32 s66, s66, s67
  v_and_b32 v6, 15, v1
  v_lshl_add_u32 v8, v6, 3, s66
  s_lshl_b32 s67, s93, 8
  s_add_u32 s67, s67, 90112
  v_bfe_u32 v9, v1, 3, 1
  v_lshlrev_b32 v9, 7, v9
  v_and_b32 v7, 7, v1
  v_lshl_add_u32 v9, v7, 3, v9
  v_add_u32 v9, s67, v9
  buffer_load_dwordx2 v[40:41], v8, s[20:23], 0 offen sc1
  buffer_load_dwordx2 v[42:43], v9, s[20:23], 0 offen sc1
  s_waitcnt lgkmcnt(0)
  s_andn2_b64 exec, exec, s[98:99]
  s_cbranch_execz L_os_141
  buffer_store_dwordx4 v[88:91], v161, s[24:27], 0 offen sc1
  s_waitcnt vmcnt(1)
L_os_141:
  s_mov_b64 exec, -1
L_r0_139:
  v_cmp_eq_u32 vcc, s53, v41
  v_cmp_eq_u32 s[72:73], s53, v43
  s_nop 0
  s_and_b64 vcc, vcc, s[72:73]
  s_cmp_eq_u64 vcc, exec
  s_cbranch_scc1 L_r0d_140
  buffer_load_dwordx2 v[40:41], v8, s[20:23], 0 offen sc1
  buffer_load_dwordx2 v[42:43], v9, s[20:23], 0 offen sc1
  s_waitcnt vmcnt(0)
  s_cmp_eq_u32 s81, 0
  s_cbranch_scc1 L_r0d_140
  s_sub_u32 s81, s81, 1
  s_branch L_r0_139
L_r0d_140:
  s_and_b32 s68, s96, 0xffff0000
  s_bitcmp1_b32 s68, 31
  s_cselect_b32 s67, 0x80000000, s80
  s_xor_b32 s68, s68, s67
  v_mov_b32 v44, s68
  v_mul_f32 v44, 0xbfb8aa3b, v44
  v_exp_f32 v44, v44
  s_nop 0
  v_add_f32 v44, 1.0, v44
  v_rcp_f32 v44, v44
  s_nop 0
  v_cvt_pk_bf16_f32 v44, v44, v44
  v_lshlrev_b32 v44, 16, v44
  v_lshlrev_b32 v45, 16, v40
  v_and_b32 v46, s80, v40
  s_lshl_b32 s68, s97, 10
  s_lshl_b32 s67, s93, 5
  s_add_u32 s68, s68, s67
  v_lshl_add_u32 v47, v1, 1, s68
  s_cmp_eq_u32 s52, 7
  s_cbranch_scc1 L_a7_142
  v_lshrrev_b32 v5, 1, v0
  v_lshlrev_b32 v5, 5, v5
  v_and_b32 v6, 1, v0
  v_lshl_add_u32 v5, v6, 4, v5
  s_lshr_b32 s68, s93, 5
  s_lshl_b32 s68, s68, 14
  s_xor_b32 s69, s0, 8192
  s_add_u32 s68, s68, s69
  s_add_u32 s68, s68, 131072
  v_add_u32 v5, s68, v5
L_aq_137:
  buffer_load_dwordx4 v[32:35], v5, s[20:23], 0 offen sc1
  s_waitcnt vmcnt(0)
  v_cmp_eq_u32 vcc, s53, v33
  v_cmp_eq_u32 s[72:73], s53, v35
  s_nop 0
  s_and_b64 vcc, vcc, s[72:73]
  s_cmp_eq_u64 vcc, exec
  s_cbranch_scc1 L_aqd_138
  s_cmp_eq_u32 s81, 0
  s_cbranch_scc1 L_aqd_138
  s_sub_u32 s81, s81, 1
  s_branch L_aq_137
L_aqd_138:
  v_lshlrev_b32 v5, 3, v0
  v_add_u32 v5, 145408, v5
  ds_write2_b32 v5, v32, v34 offset1:1
L_a7_142:
  s_mul_i32 s66, s52, 448
  s_add_u32 s66, s66, 145408
  v_lshrrev_b32 v7, 4, v1
  v_lshl_add_u32 v7, v7, 3, s66
  s_waitcnt vmcnt(0) lgkmcnt(0)
  s_barrier
  ds_read_b64 v[96:97], v7 offset:0
  ds_read_b64 v[98:99], v7 offset:32
  ds_read_b64 v[100:101], v7 offset:64
  ds_read_b64 v[102:103], v7 offset:96
  ds_read_b64 v[104:105], v7 offset:128
  ds_read_b64 v[106:107], v7 offset:160
  ds_read_b64 v[108:109], v7 offset:192
  ds_read_b64 v[110:111], v7 offset:224
  ds_read_b64 v[112:113], v7 offset:256
  ds_read_b64 v[114:115], v7 offset:288
  ds_read_b64 v[116:117], v7 offset:320
  ds_read_b64 v[118:119], v7 offset:352
  ds_read_b64 v[120:121], v7 offset:384
  ds_read_b64 v[122:123], v7 offset:416
  s_lshl_b32 s66, s52, 6
  s_add_u32 s66, s66, 149504
  v_and_b32 v48, 15, v1
  v_lshl_add_u32 v49, v48, 2, s66
  v_lshlrev_b32 v48, 2, v48
  v_add_u32 v48, 149504, v48
  s_waitcnt lgkmcnt(12)
  v_mfma_f32_16x16x32_bf16 v[32:35], v[96:99], v[128:131], 0
  s_waitcnt lgkmcnt(10)
  v_mfma_f32_16x16x32_bf16 v[36:39], v[100:103], v[132:135], 0
  s_waitcnt lgkmcnt(8)
  v_mfma_f32_16x16x32_bf16 v[32:35], v[104:107], v[136:139], v[32:35]
  s_waitcnt lgkmcnt(6)
  v_mfma_f32_16x16x32_bf16 v[36:39], v[108:111], v[140:143], v[36:39]
  s_waitcnt lgkmcnt(4)
  v_mfma_f32_16x16x32_bf16 v[32:35], v[112:115], v[144:147], v[32:35]
  s_waitcnt lgkmcnt(2)
  v_mfma_f32_16x16x32_bf16 v[36:39], v[116:119], v[148:151], v[36:39]
  s_waitcnt lgkmcnt(0)
  v_mfma_f32_16x16x32_bf16 v[32:35], v[120:123], v[152:155], v[32:35]
  s_nop 7
  v_add_f32 v32, v32, v36
  s_nop 0
  s_mov_b64 exec, 0xffff
  ds_write_b32 v49, v32
  s_mov_b64 exec, -1
  s_waitcnt lgkmcnt(0)
  s_barrier
  ds_read_b32 v64, v48 offset:0
  ds_read_b32 v65, v48 offset:64
  ds_read_b32 v66, v48 offset:128
  ds_read_b32 v67, v48 offset:192
  ds_read_b32 v68, v48 offset:256
  ds_read_b32 v69, v48 offset:320
  ds_read_b32 v70, v48 offset:384
  ds_read_b32 v71, v48 offset:448
  s_waitcnt lgkmcnt(0)
  v_add_f32 v64, v64, v65
  v_add_f32 v66, v66, v67
  v_add_f32 v68, v68, v69
  v_add_f32 v70, v70, v71
  v_add_f32 v64, v64, v66
  v_add_f32 v68, v68, v70
  v_add_f32 v32, v64, v68
  s_cmp_lg_u32 s52, 0
  s_cbranch_scc1 L_fin
  v_cvt_pk_bf16_f32 v32, v32, v32
  v_lshlrev_b32 v32, 16, v32
  v_mul_f32 v32, v32, v44
  v_cvt_pk_bf16_f32 v32, v32, v32
  v_lshlrev_b32 v32, 16, v32
  v_add_f32 v32, v32, v45
  v_cvt_pk_bf16_f32 v32, v32, v32
  v_lshlrev_b32 v32, 16, v32
  v_mul_f32 v32, v32, v42
  v_cvt_pk_bf16_f32 v32, v32, v32
  v_lshlrev_b32 v32, 16, v32
  v_add_f32 v32, v32, v46
  v_cvt_pk_bf16_f32 v32, v32, v32
  s_mov_b64 exec, 0xffff
  buffer_store_short v32, v47, s[24:27], 0 offen
L_fin:
  s_mov_b64 exec, -1
  s_cmp_lg_u32 s2, 0
  s_cbranch_scc1 L_end
  s_cmp_lg_u32 s52, 0
  s_cbranch_scc1 L_end
  v_mov_b32 v10, 0
  v_mov_b32 v11, s53
  s_mov_b64 exec, 1
  buffer_store_dword v11, v10, s[20:23], 0 offen sc1
L_end:
  s_endpgm
L_p1a:
L_pad_0:
  s_cbranch_execz L_pad_1
  s_cmp_eq_u32 s94, 0
  s_cbranch_scc1 L_p1_go
  s_barrier
  s_branch L_p1_back
L_p1_go:
  s_setprio 3
  s_lshr_b32 s70, s52, 2
  s_mul_i32 s66, s70, 1572864
  s_lshl_b32 s67, s62, 5
  s_add_u32 s66, s66, s67
  v_lshrrev_b32 v2, 1, v1
  v_mul_u32_u24 v2, 6144, v2
  v_and_b32 v3, 1, v1
  v_lshl_add_u32 v2, v3, 4, v2
  v_add_u32 v2, s66, v2
  s_lshl_b32 s71, s70, 13
  s_add_u32 s71, s71, 131072
  s_lshl_b32 s66, s70, 9
  v_lshlrev_b32 v3, 3, v1
L_pad_1:
  s_cbranch_execz L_touch_ret
  v_add_u32 v3, s66, v3
  buffer_load_dwordx2 v[144:145], v3, s[32:35], 0 offen
  s_mov_b32 s67, 0
  s_add_u32 m0, s71, 0
  s_nop 0
  buffer_load_dwordx4 v2, s[28:31], s67 offen lds
  s_add_u32 s67, s67, 196608
  s_add_u32 m0, s71, 1024
  s_nop 0
  buffer_load_dwordx4 v2, s[28:31], s67 offen lds
  s_add_u32 s67, s67, 196608
  s_add_u32 m0, s71, 2048
  s_nop 0
  buffer_load_dwordx4 v2, s[28:31], s67 offen lds
  s_add_u32 s67, s67, 196608
  s_add_u32 m0, s71, 3072
  s_nop 0
  buffer_load_dwordx4 v2, s[28:31], s67 offen lds
L_pad_2:
  s_cbranch_execz L_pad_3
  s_add_u32 s67, s67, 196608
  s_add_u32 m0, s71, 4096
  s_nop 0
  buffer_load_dwordx4 v2, s[28:31], s67 offen lds
  s_add_u32 s67, s67, 196608
  s_add_u32 m0, s71, 5120
  s_nop 0
  buffer_load_dwordx4 v2, s[28:31], s67 offen lds
  s_add_u32 s67, s67, 196608
  s_add_u32 m0, s71, 6144
  s_nop 0
  buffer_load_dwordx4 v2, s[28:31], s67 offen lds
  s_add_u32 s67, s67, 196608
  s_add_u32 m0, s71, 7168
  s_nop 0
  buffer_load_dwordx4 v2, s[28:31], s67 offen lds
  v_and_b32 v5, 15, v1
L_pad_3:
  s_cbranch_execz L_touch_ret
  v_lshlrev_b32 v5, 3, v5
  v_add_u32 v5, 154624, v5
  v_mov_b32 v10, 0
  v_mov_b32 v11, 0
  s_cmp_lg_u32 s52, 0
  s_cbranch_scc1 L_p1_noclr
  ds_write_b64 v5, v[10:11]
  s_waitcnt lgkmcnt(0)
L_p1_noclr:
  s_barrier
  s_waitcnt lgkmcnt(0)
  s_mul_i32 s53, s65, 1664525
  s_add_u32 s53, s53, 1013904223
  s_lshl_b32 s66, s52, 12
  s_add_u32 s66, s66, 98304
  v_lshl_add_u32 v3, v1, 3, s66
  v_lshrrev_b32 v7, 4, v1
L_pad_4:
  s_cbranch_execz L_pad_5
  v_lshl_add_u32 v7, v7, 3, s66
  v_lshrrev_b32 v6, 2, v1
  v_lshlrev_b32 v6, 5, v6
  v_and_b32 v8, 3, v1
  v_lshl_add_u32 v6, v8, 3, v6
  v_add_u32 v6, s71, v6
  v_mov_b32 v147, 1
  s_waitcnt vmcnt(8)
  v_lshlrev_b32 v148, 16, v144
  v_and_b32 v149, s80, v144
  v_lshlrev_b32 v150, 16, v145
  v_and_b32 v151, s80, v145
  v_mul_f32 v152, 0xbfb8aa3b, v148
L_pad_5:
  s_cbranch_execz L_touch_ret
  v_mul_f32 v153, 0xbfb8aa3b, v149
  v_mul_f32 v154, 0xbfb8aa3b, v150
  v_mul_f32 v155, 0xbfb8aa3b, v151
  v_exp_f32 v152, v152
  v_exp_f32 v153, v153
  v_exp_f32 v154, v154
  v_exp_f32 v155, v155
  v_add_f32 v152, 1.0, v152
  v_add_f32 v153, 1.0, v153
  v_add_f32 v154, 1.0, v154
  v_add_f32 v155, 1.0, v155
  v_rcp_f32 v152, v152
  v_rcp_f32 v153, v153
  v_rcp_f32 v154, v154
  v_rcp_f32 v155, v155
L_pad_6:
  s_cbranch_execz L_pad_7
  v_mul_f32 v148, v148, v152
  v_mul_f32 v149, v149, v153
  v_mul_f32 v150, v150, v154
  v_mul_f32 v151, v151, v155
  v_cvt_pk_bf16_f32 v144, v148, v149
  v_cvt_pk_bf16_f32 v145, v150, v151
  ds_write_b64 v3, v[144:145]
  s_waitcnt lgkmcnt(0)
  ds_read_b64 v[192:193], v7 offset:0
  ds_read_b64 v[194:195], v7 offset:32
  ds_read_b64 v[196:197], v7 offset:64
  ds_read_b64 v[198:199], v7 offset:96
L_pad_7:
  s_cbranch_execz L_touch_ret
  ds_read_b64 v[200:201], v7 offset:128
  ds_read_b64 v[202:203], v7 offset:160
  ds_read_b64 v[204:205], v7 offset:192
  ds_read_b64 v[206:207], v7 offset:224
  ds_read_b64 v[208:209], v7 offset:256
  ds_read_b64 v[210:211], v7 offset:288
  ds_read_b64 v[212:213], v7 offset:320
  ds_read_b64 v[214:215], v7 offset:352
  ds_read_b64 v[216:217], v7 offset:384
  ds_read_b64 v[218:219], v7 offset:416
  ds_read_b64 v[220:221], v7 offset:448
L_pad_8:
  s_cbranch_execz L_pad_9
  ds_read_b64 v[222:223], v7 offset:480
  s_waitcnt vmcnt(7)
  ds_read_b64_tr_b16 v[156:157], v6 offset:0
  ds_read_b64_tr_b16 v[158:159], v6 offset:512
  s_waitcnt vmcnt(6)
  ds_read_b64_tr_b16 v[160:161], v6 offset:1024
  ds_read_b64_tr_b16 v[162:163], v6 offset:1536
  s_waitcnt vmcnt(5)
  ds_read_b64_tr_b16 v[164:165], v6 offset:2048
  ds_read_b64_tr_b16 v[166:167], v6 offset:2560
  s_waitcnt vmcnt(4)
  ds_read_b64_tr_b16 v[168:169], v6 offset:3072
  ds_read_b64_tr_b16 v[170:171], v6 offset:3584
  s_waitcnt vmcnt(3)
L_pad_9:
  s_cbranch_execz L_touch_ret
  ds_read_b64_tr_b16 v[172:173], v6 offset:4096
  ds_read_b64_tr_b16 v[174:175], v6 offset:4608
  s_waitcnt vmcnt(2)
  ds_read_b64_tr_b16 v[176:177], v6 offset:5120
  ds_read_b64_tr_b16 v[178:179], v6 offset:5632
  s_waitcnt vmcnt(1)
  ds_read_b64_tr_b16 v[180:181], v6 offset:6144
  ds_read_b64_tr_b16 v[182:183], v6 offset:6656
  s_waitcnt vmcnt(0)
  ds_read_b64_tr_b16 v[184:185], v6 offset:7168
  ds_read_b64_tr_b16 v[186:187], v6 offset:7680
  s_waitcnt lgkmcnt(12)
  v_mfma_f32_16x16x32_bf16 v[148:151], v[192:195], v[156:159], 0
  v_mfma_f32_16x16x32_bf16 v[152:155], v[196:199], v[160:163], 0
L_pad_10:
  s_cbranch_execz L_pad_11
  s_waitcnt lgkmcnt(8)
  v_mfma_f32_16x16x32_bf16 v[148:151], v[200:203], v[164:167], v[148:151]
  v_mfma_f32_16x16x32_bf16 v[152:155], v[204:207], v[168:171], v[152:155]
  s_waitcnt lgkmcnt(4)
  v_mfma_f32_16x16x32_bf16 v[148:151], v[208:211], v[172:175], v[148:151]
  v_mfma_f32_16x16x32_bf16 v[152:155], v[212:215], v[176:179], v[152:155]
  s_waitcnt lgkmcnt(0)
  v_mfma_f32_16x16x32_bf16 v[148:151], v[216:219], v[180:183], v[148:151]
  v_mfma_f32_16x16x32_bf16 v[152:155], v[220:223], v[184:187], v[152:155]
  s_nop 7
  v_add_f32 v146, v148, v152
  s_cmp_eq_u32 s52, 0
  s_cbranch_scc1 L_p1_w0
  s_mov_b64 exec, 0xffff
L_pad_11:
  s_cbranch_execz L_touch_ret
  ds_write_b64 v5, v[146:147]
  s_mov_b64 exec, -1
  s_branch L_p1_fin
L_p1_w0:
  ds_read_b64 v[10:11], v5
  s_waitcnt lgkmcnt(0)
  v_cmp_eq_u32 vcc, 1, v11
  s_nop 0
  s_cmp_eq_u64 vcc, exec
  s_cbranch_scc1 L_p1_got
  s_cmp_eq_u32 s81, 0
  s_cbranch_scc1 L_p1_got
  s_sub_u32 s81, s81, 1
  s_branch L_p1_w0
L_p1_got:
  v_add_f32 v152, v146, v10
  v_cvt_pk_bf16_f32 v152, v152, v152
  v_lshlrev_b32 v152, 16, v152
  s_cmp_lt_u32 s62, 32
  s_cbranch_scc1 L_p1_sa
L_pad_12:
  s_cbranch_execz L_pad_13
  v_add_f32 v152, 1.0, v152
L_p1_sa:
  s_nop 1
  v_mov_b32_dpp v154, v152 quad_perm:[1,0,3,2] row_mask:0xf bank_mask:0xf
  v_cvt_pk_bf16_f32 v152, v152, v154
  v_mov_b32 v153, s53
  s_lshl_b32 s67, s62, 7
  s_add_u32 s67, s67, 4096
  v_lshlrev_b32 v3, 2, v1
  v_add_u32 v3, s67, v3
  s_mov_b64 exec, 0x5555
  buffer_store_dwordx2 v[152:153], v3, s[20:23], 0 offen sc1
  s_mov_b64 exec, -1
L_p1_fin:
  s_lshl_b32 s66, s56, 7
  s_lshl_b32 s67, s64, 5
  s_add_u32 s66, s66, s67
L_pad_13:
  s_cbranch_execz L_touch_ret
  v_lshrrev_b32 v4, 3, v1
  v_add_u32 v4, s66, v4
  v_lshlrev_b32 v4, 10, v4
  v_and_b32 v5, 7, v1
  v_lshl_add_u32 v4, v5, 4, v4
  s_lshl_b32 s67, s63, 9
  v_add_u32 v4, s67, v4
  s_add_u32 s66, s96, 0
  s_and_b32 s66, s66, 3
  s_lshl_b32 s66, s66, 7
  v_add_u32 v252, s66, v4
  s_add_u32 s66, s96, 1
  s_and_b32 s66, s66, 3
  s_lshl_b32 s66, s66, 7
  v_add_u32 v253, s66, v4
L_pad_14:
  s_cbranch_execz L_pad_15
  s_add_u32 s66, s96, 2
  s_and_b32 s66, s66, 3
  s_lshl_b32 s66, s66, 7
  v_add_u32 v254, s66, v4
  s_add_u32 s66, s96, 3
  s_and_b32 s66, s66, 3
  s_lshl_b32 s66, s66, 7
  v_add_u32 v255, s66, v4
  buffer_load_dwordx4 v[32:35], v252, s[8:11], 0 offen
  buffer_load_dwordx4 v[36:39], v252, s[8:11], s86 offen
  buffer_load_dwordx4 v[40:43], v252, s[8:11], s87 offen
  buffer_load_dwordx4 v[44:47], v252, s[8:11], s88 offen
  buffer_load_dwordx4 v[64:67], v253, s[8:11], 0 offen
  buffer_load_dwordx4 v[68:71], v253, s[8:11], s86 offen
  buffer_load_dwordx4 v[72:75], v253, s[8:11], s87 offen
  buffer_load_dwordx4 v[76:79], v253, s[8:11], s88 offen
  buffer_load_dwordx4 v[96:99], v254, s[8:11], 0 offen
  buffer_load_dwordx4 v[100:103], v254, s[8:11], s86 offen
  buffer_load_dwordx4 v[104:107], v254, s[8:11], s87 offen
  buffer_load_dwordx4 v[108:111], v254, s[8:11], s88 offen
  buffer_load_dwordx4 v[128:131], v255, s[8:11], 0 offen
  buffer_load_dwordx4 v[132:135], v255, s[8:11], s86 offen
  buffer_load_dwordx4 v[136:139], v255, s[8:11], s87 offen
  buffer_load_dwordx4 v[140:143], v255, s[8:11], s88 offen
L_pad_15:
  s_cbranch_execz L_touch_ret
  s_mov_b32 s98, 1
  s_setprio 0
  s_branch L_x_issued
L_code_end:
.section .rodata,"a"
.p2align 6
.amdhsa_kernel adaLN_cond__mha_block__moe_arch_mod__prompt_kernel
  .amdhsa_next_free_vgpr 256
  .amdhsa_next_free_sgpr 102
  .amdhsa_accum_offset 256
  .amdhsa_group_segment_fixed_size 0
  .amdhsa_kernarg_size 104
  .amdhsa_user_sgpr_count 2
  .amdhsa_user_sgpr_kernarg_segment_ptr 1
  .amdhsa_system_sgpr_workgroup_id_x 1
.end_amdhsa_kernel
```
